```python
import torch

def _softmax(x, axis=-1):
    return torch.softmax(x, dim=axis)
def _gelu(x):
    return torch.nn.functional.gelu(x, approximate="tanh")
def _silu(x):
    return torch.nn.functional.silu(x)
def _sigmoid(x):
    return torch.sigmoid(x)
def _layernorm(x, axis=-1, eps=1e-5):
    m = x.mean(dim=axis, keepdim=True)
    v = x.var(dim=axis, keepdim=True, unbiased=False)
    return (x - m) / torch.sqrt(v + eps)
def _scatter_add(tgt, idx, src, axis=0):
    return tgt.clone().index_add_(axis, idx, src)
def _segment_sum(src, seg, n):
    out = torch.zeros((n,) + src.shape[1:], dtype=src.dtype)
    return out.index_add_(0, seg, src)
def _pad(x, pw):
    flat = tuple(v for pair in reversed(pw) for v in pair)
    return torch.nn.functional.pad(x, flat)

kernel_name = 'standalone__mha_block_cached__near_ridge'

def setup_inputs():

    _w = (lambda a: (lambda t: t.to(torch.bfloat16) if t.is_floating_point() else t)(torch.as_tensor(a)))
    B, Sq, D = 8, 128, 1024
    H, Sk, Dh = 32, 1024, 128
    return {
        "x": _w((lambda *s: torch.randn(*s, dtype=torch.bfloat16) * 0.8)(B, Sq, D)),
        "k_cache": _w((lambda *s: torch.randn(*s, dtype=torch.bfloat16) * 0.8)(B, H, Sk, Dh)),
        "v_cache": _w((lambda *s: torch.randn(*s, dtype=torch.bfloat16) * 0.05)(B, H, Sk, Dh)),
        "wq": _w((lambda *s: torch.randn(*s, dtype=torch.bfloat16) * 0.8)(D, H * Dh) * (D ** -0.5)),
        "wo": _w((lambda *s: torch.randn(*s, dtype=torch.bfloat16) * 0.05)(H * Dh, D) * ((H * Dh) ** -0.5)),
    }

def reference(x, k_cache, v_cache, wq, wo):
    B, Sq, D = x.shape
    H, Dh = 32, 128
    q = (lambda x, *d: x.permute(*d))((x @ wq).reshape(B, Sq, H, Dh), 0, 2, 1, 3)
    scores = torch.einsum("bhqd,bhkd->bhqk", q, k_cache) * (Dh ** -0.5)
    p = _softmax(scores, axis=-1)
    o = torch.einsum("bhqk,bhkd->bhqd", p, v_cache)
    return (lambda x, *d: x.permute(*d))(o, 0, 2, 1, 3).reshape(B, Sq, H * Dh) @ wo
```

```asm
; @launch grid=(256,1,1) block=(512,1,1) lds=163840
.amdgcn_target "amdgcn-amd-amdhsa--gfx950"
.text
.globl standalone__mha_block_cached__near_ridge_kernel
.p2align 8
.type standalone__mha_block_cached__near_ridge_kernel,@function
standalone__mha_block_cached__near_ridge_kernel:
    s_cmp_ge_u32 s2, 256
    s_cbranch_scc1 K1_END
    s_load_dwordx4 s[4:7], s[0:1], 0
    s_load_dwordx4 s[8:11], s[0:1], 16
    s_load_dwordx4 s[68:71], s[0:1], 32
    s_load_dwordx2 s[72:73], s[0:1], 48
    s_load_dwordx2 s[12:13], s[0:1], 56
    v_lshrrev_b32 v1, 6, v0
    v_and_b32 v0, 63, v0
    v_readfirstlane_b32 s14, v1
    s_and_b32 s40, s2, 7
    s_lshr_b32 s41, s2, 3
    s_lshr_b32 s15, s40, 2
    s_lshl_b32 s15, s15, 2
    s_lshr_b32 s42, s41, 3
    s_add_u32 s15, s15, s42
    s_and_b32 s18, s40, 3
    s_and_b32 s19, s41, 7
    s_lshl_b32 s16, s18, 3
    s_add_u32 s16, s16, s19
    s_lshl_b32 s17, s15, 5
    s_add_u32 s17, s17, s16
    v_lshlrev_b32 v2, 2, v0
    v_add_u32 v2, 147456, v2
    v_mov_b32 v3, 0
    ds_write_b32 v2, v3
    s_waitcnt lgkmcnt(0)
    s_mov_b32 s36, s12
    s_mov_b32 s37, s13
    s_mov_b32 s38, 0x4000000
    s_mov_b32 s39, 0x20000
    s_mov_b32 s76, s72
    s_mov_b32 s77, s73
    s_mov_b32 s78, 256
    s_mov_b32 s79, 0x20000
    s_mov_b32 s58, 2097152
    s_cmp_ge_u32 s14, 4
    s_cbranch_scc1 K1_LOADER
    s_getpc_b64 s[60:61]
PCL:
    s_sub_u32 s60, s60, PCL-standalone__mha_block_cached__near_ridge_kernel
    s_subb_u32 s61, s61, 0
    s_mov_b32 s64, s60
    s_mov_b32 s65, s61
    s_mov_b32 s66, K1_END-standalone__mha_block_cached__near_ridge_kernel
    s_mov_b32 s67, 0x20000
    s_lshr_b32 s62, s2, 3
    s_and_b32 s62, s62, 7
    s_lshl_b32 s62, s62, 2
    s_add_u32 s62, s62, s14
    s_lshl_b32 s62, s62, 10
    v_lshlrev_b32 v244, 4, v0
    buffer_load_dwordx4 v[100:103], v244, s[64:67], s62 offen
    v_mov_b32 v252, v0
    v_mov_b32 v250, 147456
    s_lshl_b32 s40, s14, 2
    v_add_u32 v251, s40, v250
    v_mov_b32 v249, 0
    v_and_b32 v236, 31, v252
    v_lshrrev_b32 v237, 5, v252
    v_bfe_u32 v238, v252, 2, 2
    v_bfe_u32 v245, v252, 4, 1
    v_and_b32 v246, 3, v252
    v_lshlrev_b32 v246, 3, v246
    v_lshl_add_u32 v239, v245, 5, v246
    v_lshrrev_b32 v244, 4, v252
    v_lshl_add_u32 v245, v244, 3, v238
    v_and_b32 v246, 3, v252
    v_lshlrev_b32 v246, 3, v246
    v_lshl_add_u32 v245, v245, 8, v246
    v_add_u32 v245, 65536, v245
    v_and_b32 v246, 1, v244
    v_lshl_add_u32 v246, v238, 1, v246
    v_xor_b32 v247, 0, v246
    v_lshl_add_u32 v226, v247, 5, v245
    v_xor_b32 v247, 1, v246
    v_lshl_add_u32 v227, v247, 5, v245
    v_xor_b32 v247, 2, v246
    v_lshl_add_u32 v228, v247, 5, v245
    v_xor_b32 v247, 3, v246
    v_lshl_add_u32 v229, v247, 5, v245
    v_xor_b32 v247, 4, v246
    v_lshl_add_u32 v230, v247, 5, v245
    v_xor_b32 v247, 5, v246
    v_lshl_add_u32 v231, v247, 5, v245
    v_xor_b32 v247, 6, v246
    v_lshl_add_u32 v232, v247, 5, v245
    v_xor_b32 v247, 7, v246
    v_lshl_add_u32 v233, v247, 5, v245
    v_and_b32 v245, 15, v252
    s_lshl_b32 s40, s14, 5
    v_add_u32 v245, s40, v245
    v_bfe_u32 v246, v245, 1, 3
    v_add_u32 v247, 0, v244
    v_xor_b32 v247, v247, v246
    v_lshlrev_b32 v247, 4, v247
    v_lshl_add_u32 v224, v245, 7, v247
    v_add_u32 v247, 4, v244
    v_xor_b32 v247, v247, v246
    v_lshlrev_b32 v247, 4, v247
    v_lshl_add_u32 v225, v245, 7, v247
    s_mov_b32 s88, 0
    s_mov_b32 s90, 0
    s_waitcnt vmcnt(0)
GEMM:
    v_mov_b32 v0, 0
    v_mov_b32 v1, 0
    v_mov_b32 v2, 0
    v_mov_b32 v3, 0
    v_mov_b32 v4, 0
    v_mov_b32 v5, 0
    v_mov_b32 v6, 0
    v_mov_b32 v7, 0
    v_mov_b32 v8, 0
    v_mov_b32 v9, 0
    v_mov_b32 v10, 0
    v_mov_b32 v11, 0
    v_mov_b32 v12, 0
    v_mov_b32 v13, 0
    v_mov_b32 v14, 0
    v_mov_b32 v15, 0
    v_mov_b32 v16, 0
    v_mov_b32 v17, 0
    v_mov_b32 v18, 0
    v_mov_b32 v19, 0
    v_mov_b32 v20, 0
    v_mov_b32 v21, 0
    v_mov_b32 v22, 0
    v_mov_b32 v23, 0
    v_mov_b32 v24, 0
    v_mov_b32 v25, 0
    v_mov_b32 v26, 0
    v_mov_b32 v27, 0
    v_mov_b32 v28, 0
    v_mov_b32 v29, 0
    v_mov_b32 v30, 0
    v_mov_b32 v31, 0
    v_mov_b32 v32, 0
    v_mov_b32 v33, 0
    v_mov_b32 v34, 0
    v_mov_b32 v35, 0
    v_mov_b32 v36, 0
    v_mov_b32 v37, 0
    v_mov_b32 v38, 0
    v_mov_b32 v39, 0
    v_mov_b32 v40, 0
    v_mov_b32 v41, 0
    v_mov_b32 v42, 0
    v_mov_b32 v43, 0
    v_mov_b32 v44, 0
    v_mov_b32 v45, 0
    v_mov_b32 v46, 0
    v_mov_b32 v47, 0
    v_mov_b32 v48, 0
    v_mov_b32 v49, 0
    v_mov_b32 v50, 0
    v_mov_b32 v51, 0
    v_mov_b32 v52, 0
    v_mov_b32 v53, 0
    v_mov_b32 v54, 0
    v_mov_b32 v55, 0
    v_mov_b32 v56, 0
    v_mov_b32 v57, 0
    v_mov_b32 v58, 0
    v_mov_b32 v59, 0
    v_mov_b32 v60, 0
    v_mov_b32 v61, 0
    v_mov_b32 v62, 0
    v_mov_b32 v63, 0
    s_barrier
    ds_read_b128 v[64:67], v224 offset:0
    ds_read_b128 v[68:71], v224 offset:2048
    ds_read_b64_tr_b16 v[96:97], v226 offset:0
    ds_read_b64_tr_b16 v[98:99], v226 offset:1024
    ds_read_b64_tr_b16 v[100:101], v227 offset:0
    ds_read_b64_tr_b16 v[102:103], v227 offset:1024
    ds_read_b64_tr_b16 v[104:105], v228 offset:0
    ds_read_b64_tr_b16 v[106:107], v228 offset:1024
    ds_read_b64_tr_b16 v[108:109], v229 offset:0
    ds_read_b64_tr_b16 v[110:111], v229 offset:1024
    ds_read_b64_tr_b16 v[112:113], v230 offset:0
    ds_read_b64_tr_b16 v[114:115], v230 offset:1024
    ds_read_b64_tr_b16 v[116:117], v231 offset:0
    ds_read_b64_tr_b16 v[118:119], v231 offset:1024
    ds_read_b64_tr_b16 v[120:121], v232 offset:0
    ds_read_b64_tr_b16 v[122:123], v232 offset:1024
    ds_read_b64_tr_b16 v[124:125], v233 offset:0
    ds_read_b64_tr_b16 v[126:127], v233 offset:1024
    ds_read_b128 v[72:75], v225 offset:0
    ds_read_b128 v[76:79], v225 offset:2048
    ds_read_b64_tr_b16 v[128:129], v226 offset:8192
    ds_read_b64_tr_b16 v[130:131], v226 offset:9216
    ds_read_b64_tr_b16 v[132:133], v227 offset:8192
    ds_read_b64_tr_b16 v[134:135], v227 offset:9216
    ds_read_b64_tr_b16 v[136:137], v228 offset:8192
    ds_read_b64_tr_b16 v[138:139], v228 offset:9216
    ds_read_b64_tr_b16 v[140:141], v229 offset:8192
    ds_read_b64_tr_b16 v[142:143], v229 offset:9216
    ds_read_b64_tr_b16 v[144:145], v230 offset:8192
    ds_read_b64_tr_b16 v[146:147], v230 offset:9216
    ds_read_b64_tr_b16 v[148:149], v231 offset:8192
    ds_read_b64_tr_b16 v[150:151], v231 offset:9216
    ds_read_b64_tr_b16 v[152:153], v232 offset:8192
    ds_read_b64_tr_b16 v[154:155], v232 offset:9216
    ds_read_b64_tr_b16 v[156:157], v233 offset:8192
    ds_read_b64_tr_b16 v[158:159], v233 offset:9216
    s_waitcnt lgkmcnt(0)
    s_mov_b32 s51, 4
GLOOP:
    v_mfma_f32_16x16x32_bf16 v[0:3], v[96:99], v[64:67], v[0:3]
    v_mfma_f32_16x16x32_bf16 v[4:7], v[96:99], v[68:71], v[4:7]
    s_barrier
    v_mfma_f32_16x16x32_bf16 v[8:11], v[100:103], v[64:67], v[8:11]
    ds_read_b128 v[80:83], v224 offset:16384
    ds_read_b128 v[84:87], v224 offset:18432
    v_mfma_f32_16x16x32_bf16 v[12:15], v[100:103], v[68:71], v[12:15]
    ds_read_b64_tr_b16 v[160:161], v226 offset:16384
    v_mfma_f32_16x16x32_bf16 v[16:19], v[104:107], v[64:67], v[16:19]
    ds_read_b64_tr_b16 v[162:163], v226 offset:17408
    ds_read_b64_tr_b16 v[164:165], v227 offset:16384
    v_mfma_f32_16x16x32_bf16 v[20:23], v[104:107], v[68:71], v[20:23]
    ds_read_b64_tr_b16 v[166:167], v227 offset:17408
    v_mfma_f32_16x16x32_bf16 v[24:27], v[108:111], v[64:67], v[24:27]
    ds_read_b64_tr_b16 v[168:169], v228 offset:16384
    ds_read_b64_tr_b16 v[170:171], v228 offset:17408
    v_mfma_f32_16x16x32_bf16 v[28:31], v[108:111], v[68:71], v[28:31]
    ds_read_b64_tr_b16 v[172:173], v229 offset:16384
    v_mfma_f32_16x16x32_bf16 v[32:35], v[112:115], v[64:67], v[32:35]
    ds_read_b64_tr_b16 v[174:175], v229 offset:17408
    ds_read_b64_tr_b16 v[176:177], v230 offset:16384
    v_mfma_f32_16x16x32_bf16 v[36:39], v[112:115], v[68:71], v[36:39]
    ds_read_b64_tr_b16 v[178:179], v230 offset:17408
    v_mfma_f32_16x16x32_bf16 v[40:43], v[116:119], v[64:67], v[40:43]
    ds_read_b64_tr_b16 v[180:181], v231 offset:16384
    ds_read_b64_tr_b16 v[182:183], v231 offset:17408
    v_mfma_f32_16x16x32_bf16 v[44:47], v[116:119], v[68:71], v[44:47]
    ds_read_b64_tr_b16 v[184:185], v232 offset:16384
    v_mfma_f32_16x16x32_bf16 v[48:51], v[120:123], v[64:67], v[48:51]
    ds_read_b64_tr_b16 v[186:187], v232 offset:17408
    ds_read_b64_tr_b16 v[188:189], v233 offset:16384
    v_mfma_f32_16x16x32_bf16 v[52:55], v[120:123], v[68:71], v[52:55]
    ds_read_b64_tr_b16 v[190:191], v233 offset:17408
    v_mfma_f32_16x16x32_bf16 v[56:59], v[124:127], v[64:67], v[56:59]
    ds_read_b128 v[88:91], v225 offset:16384
    ds_read_b128 v[92:95], v225 offset:18432
    v_mfma_f32_16x16x32_bf16 v[60:63], v[124:127], v[68:71], v[60:63]
    ds_read_b64_tr_b16 v[192:193], v226 offset:24576
    v_mfma_f32_16x16x32_bf16 v[0:3], v[128:131], v[72:75], v[0:3]
    ds_read_b64_tr_b16 v[194:195], v226 offset:25600
    ds_read_b64_tr_b16 v[196:197], v227 offset:24576
    v_mfma_f32_16x16x32_bf16 v[4:7], v[128:131], v[76:79], v[4:7]
    ds_read_b64_tr_b16 v[198:199], v227 offset:25600
    v_mfma_f32_16x16x32_bf16 v[8:11], v[132:135], v[72:75], v[8:11]
    ds_read_b64_tr_b16 v[200:201], v228 offset:24576
    ds_read_b64_tr_b16 v[202:203], v228 offset:25600
    v_mfma_f32_16x16x32_bf16 v[12:15], v[132:135], v[76:79], v[12:15]
    ds_read_b64_tr_b16 v[204:205], v229 offset:24576
    v_mfma_f32_16x16x32_bf16 v[16:19], v[136:139], v[72:75], v[16:19]
    ds_read_b64_tr_b16 v[206:207], v229 offset:25600
    ds_read_b64_tr_b16 v[208:209], v230 offset:24576
    v_mfma_f32_16x16x32_bf16 v[20:23], v[136:139], v[76:79], v[20:23]
    ds_read_b64_tr_b16 v[210:211], v230 offset:25600
    v_mfma_f32_16x16x32_bf16 v[24:27], v[140:143], v[72:75], v[24:27]
    ds_read_b64_tr_b16 v[212:213], v231 offset:24576
    ds_read_b64_tr_b16 v[214:215], v231 offset:25600
    v_mfma_f32_16x16x32_bf16 v[28:31], v[140:143], v[76:79], v[28:31]
    ds_read_b64_tr_b16 v[216:217], v232 offset:24576
    v_mfma_f32_16x16x32_bf16 v[32:35], v[144:147], v[72:75], v[32:35]
    ds_read_b64_tr_b16 v[218:219], v232 offset:25600
    ds_read_b64_tr_b16 v[220:221], v233 offset:24576
    v_mfma_f32_16x16x32_bf16 v[36:39], v[144:147], v[76:79], v[36:39]
    ds_read_b64_tr_b16 v[222:223], v233 offset:25600
    v_mfma_f32_16x16x32_bf16 v[40:43], v[148:151], v[72:75], v[40:43]
    v_mfma_f32_16x16x32_bf16 v[44:47], v[148:151], v[76:79], v[44:47]
    v_mfma_f32_16x16x32_bf16 v[48:51], v[152:155], v[72:75], v[48:51]
    v_mfma_f32_16x16x32_bf16 v[52:55], v[152:155], v[76:79], v[52:55]
    v_mfma_f32_16x16x32_bf16 v[56:59], v[156:159], v[72:75], v[56:59]
    v_mfma_f32_16x16x32_bf16 v[60:63], v[156:159], v[76:79], v[60:63]
    s_waitcnt lgkmcnt(0)
    s_cmp_lg_u32 s90, 0
    s_cbranch_scc1 SIG1
SIG1_BACK:
    v_mfma_f32_16x16x32_bf16 v[0:3], v[160:163], v[80:83], v[0:3]
    v_mfma_f32_16x16x32_bf16 v[4:7], v[160:163], v[84:87], v[4:7]
    s_barrier
    v_mfma_f32_16x16x32_bf16 v[8:11], v[164:167], v[80:83], v[8:11]
    ds_read_b128 v[64:67], v224 offset:32768
    ds_read_b128 v[68:71], v224 offset:34816
    v_mfma_f32_16x16x32_bf16 v[12:15], v[164:167], v[84:87], v[12:15]
    ds_read_b64_tr_b16 v[96:97], v226 offset:32768
    v_mfma_f32_16x16x32_bf16 v[16:19], v[168:171], v[80:83], v[16:19]
    ds_read_b64_tr_b16 v[98:99], v226 offset:33792
    ds_read_b64_tr_b16 v[100:101], v227 offset:32768
    v_mfma_f32_16x16x32_bf16 v[20:23], v[168:171], v[84:87], v[20:23]
    ds_read_b64_tr_b16 v[102:103], v227 offset:33792
    v_mfma_f32_16x16x32_bf16 v[24:27], v[172:175], v[80:83], v[24:27]
    ds_read_b64_tr_b16 v[104:105], v228 offset:32768
    ds_read_b64_tr_b16 v[106:107], v228 offset:33792
    v_mfma_f32_16x16x32_bf16 v[28:31], v[172:175], v[84:87], v[28:31]
    ds_read_b64_tr_b16 v[108:109], v229 offset:32768
    v_mfma_f32_16x16x32_bf16 v[32:35], v[176:179], v[80:83], v[32:35]
    ds_read_b64_tr_b16 v[110:111], v229 offset:33792
    ds_read_b64_tr_b16 v[112:113], v230 offset:32768
    v_mfma_f32_16x16x32_bf16 v[36:39], v[176:179], v[84:87], v[36:39]
    ds_read_b64_tr_b16 v[114:115], v230 offset:33792
    v_mfma_f32_16x16x32_bf16 v[40:43], v[180:183], v[80:83], v[40:43]
    ds_read_b64_tr_b16 v[116:117], v231 offset:32768
    ds_read_b64_tr_b16 v[118:119], v231 offset:33792
    v_mfma_f32_16x16x32_bf16 v[44:47], v[180:183], v[84:87], v[44:47]
    ds_read_b64_tr_b16 v[120:121], v232 offset:32768
    v_mfma_f32_16x16x32_bf16 v[48:51], v[184:187], v[80:83], v[48:51]
    ds_read_b64_tr_b16 v[122:123], v232 offset:33792
    ds_read_b64_tr_b16 v[124:125], v233 offset:32768
    v_mfma_f32_16x16x32_bf16 v[52:55], v[184:187], v[84:87], v[52:55]
    ds_read_b64_tr_b16 v[126:127], v233 offset:33792
    v_mfma_f32_16x16x32_bf16 v[56:59], v[188:191], v[80:83], v[56:59]
    ds_read_b128 v[72:75], v225 offset:32768
    ds_read_b128 v[76:79], v225 offset:34816
    v_mfma_f32_16x16x32_bf16 v[60:63], v[188:191], v[84:87], v[60:63]
    ds_read_b64_tr_b16 v[128:129], v226 offset:40960
    v_mfma_f32_16x16x32_bf16 v[0:3], v[192:195], v[88:91], v[0:3]
    ds_read_b64_tr_b16 v[130:131], v226 offset:41984
    ds_read_b64_tr_b16 v[132:133], v227 offset:40960
    v_mfma_f32_16x16x32_bf16 v[4:7], v[192:195], v[92:95], v[4:7]
    ds_read_b64_tr_b16 v[134:135], v227 offset:41984
    v_mfma_f32_16x16x32_bf16 v[8:11], v[196:199], v[88:91], v[8:11]
    ds_read_b64_tr_b16 v[136:137], v228 offset:40960
    ds_read_b64_tr_b16 v[138:139], v228 offset:41984
    v_mfma_f32_16x16x32_bf16 v[12:15], v[196:199], v[92:95], v[12:15]
    ds_read_b64_tr_b16 v[140:141], v229 offset:40960
    v_mfma_f32_16x16x32_bf16 v[16:19], v[200:203], v[88:91], v[16:19]
    ds_read_b64_tr_b16 v[142:143], v229 offset:41984
    ds_read_b64_tr_b16 v[144:145], v230 offset:40960
    v_mfma_f32_16x16x32_bf16 v[20:23], v[200:203], v[92:95], v[20:23]
    ds_read_b64_tr_b16 v[146:147], v230 offset:41984
    v_mfma_f32_16x16x32_bf16 v[24:27], v[204:207], v[88:91], v[24:27]
    ds_read_b64_tr_b16 v[148:149], v231 offset:40960
    ds_read_b64_tr_b16 v[150:151], v231 offset:41984
    v_mfma_f32_16x16x32_bf16 v[28:31], v[204:207], v[92:95], v[28:31]
    ds_read_b64_tr_b16 v[152:153], v232 offset:40960
    v_mfma_f32_16x16x32_bf16 v[32:35], v[208:211], v[88:91], v[32:35]
    ds_read_b64_tr_b16 v[154:155], v232 offset:41984
    ds_read_b64_tr_b16 v[156:157], v233 offset:40960
    v_mfma_f32_16x16x32_bf16 v[36:39], v[208:211], v[92:95], v[36:39]
    ds_read_b64_tr_b16 v[158:159], v233 offset:41984
    v_mfma_f32_16x16x32_bf16 v[40:43], v[212:215], v[88:91], v[40:43]
    v_mfma_f32_16x16x32_bf16 v[44:47], v[212:215], v[92:95], v[44:47]
    v_mfma_f32_16x16x32_bf16 v[48:51], v[216:219], v[88:91], v[48:51]
    v_mfma_f32_16x16x32_bf16 v[52:55], v[216:219], v[92:95], v[52:55]
    v_mfma_f32_16x16x32_bf16 v[56:59], v[220:223], v[88:91], v[56:59]
    v_mfma_f32_16x16x32_bf16 v[60:63], v[220:223], v[92:95], v[60:63]
    s_waitcnt lgkmcnt(0)
    v_mfma_f32_16x16x32_bf16 v[0:3], v[96:99], v[64:67], v[0:3]
    v_mfma_f32_16x16x32_bf16 v[4:7], v[96:99], v[68:71], v[4:7]
    s_barrier
    v_mfma_f32_16x16x32_bf16 v[8:11], v[100:103], v[64:67], v[8:11]
    ds_read_b128 v[80:83], v224 offset:49152
    ds_read_b128 v[84:87], v224 offset:51200
    v_mfma_f32_16x16x32_bf16 v[12:15], v[100:103], v[68:71], v[12:15]
    ds_read_b64_tr_b16 v[160:161], v226 offset:49152
    v_mfma_f32_16x16x32_bf16 v[16:19], v[104:107], v[64:67], v[16:19]
    ds_read_b64_tr_b16 v[162:163], v226 offset:50176
    ds_read_b64_tr_b16 v[164:165], v227 offset:49152
    v_mfma_f32_16x16x32_bf16 v[20:23], v[104:107], v[68:71], v[20:23]
    ds_read_b64_tr_b16 v[166:167], v227 offset:50176
    v_mfma_f32_16x16x32_bf16 v[24:27], v[108:111], v[64:67], v[24:27]
    ds_read_b64_tr_b16 v[168:169], v228 offset:49152
    ds_read_b64_tr_b16 v[170:171], v228 offset:50176
    v_mfma_f32_16x16x32_bf16 v[28:31], v[108:111], v[68:71], v[28:31]
    ds_read_b64_tr_b16 v[172:173], v229 offset:49152
    v_mfma_f32_16x16x32_bf16 v[32:35], v[112:115], v[64:67], v[32:35]
    ds_read_b64_tr_b16 v[174:175], v229 offset:50176
    ds_read_b64_tr_b16 v[176:177], v230 offset:49152
    v_mfma_f32_16x16x32_bf16 v[36:39], v[112:115], v[68:71], v[36:39]
    ds_read_b64_tr_b16 v[178:179], v230 offset:50176
    v_mfma_f32_16x16x32_bf16 v[40:43], v[116:119], v[64:67], v[40:43]
    ds_read_b64_tr_b16 v[180:181], v231 offset:49152
    ds_read_b64_tr_b16 v[182:183], v231 offset:50176
    v_mfma_f32_16x16x32_bf16 v[44:47], v[116:119], v[68:71], v[44:47]
    ds_read_b64_tr_b16 v[184:185], v232 offset:49152
    v_mfma_f32_16x16x32_bf16 v[48:51], v[120:123], v[64:67], v[48:51]
    ds_read_b64_tr_b16 v[186:187], v232 offset:50176
    ds_read_b64_tr_b16 v[188:189], v233 offset:49152
    v_mfma_f32_16x16x32_bf16 v[52:55], v[120:123], v[68:71], v[52:55]
    ds_read_b64_tr_b16 v[190:191], v233 offset:50176
    v_mfma_f32_16x16x32_bf16 v[56:59], v[124:127], v[64:67], v[56:59]
    ds_read_b128 v[88:91], v225 offset:49152
    ds_read_b128 v[92:95], v225 offset:51200
    v_mfma_f32_16x16x32_bf16 v[60:63], v[124:127], v[68:71], v[60:63]
    ds_read_b64_tr_b16 v[192:193], v226 offset:57344
    v_mfma_f32_16x16x32_bf16 v[0:3], v[128:131], v[72:75], v[0:3]
    ds_read_b64_tr_b16 v[194:195], v226 offset:58368
    ds_read_b64_tr_b16 v[196:197], v227 offset:57344
    v_mfma_f32_16x16x32_bf16 v[4:7], v[128:131], v[76:79], v[4:7]
    ds_read_b64_tr_b16 v[198:199], v227 offset:58368
    v_mfma_f32_16x16x32_bf16 v[8:11], v[132:135], v[72:75], v[8:11]
    ds_read_b64_tr_b16 v[200:201], v228 offset:57344
    ds_read_b64_tr_b16 v[202:203], v228 offset:58368
    v_mfma_f32_16x16x32_bf16 v[12:15], v[132:135], v[76:79], v[12:15]
    ds_read_b64_tr_b16 v[204:205], v229 offset:57344
    v_mfma_f32_16x16x32_bf16 v[16:19], v[136:139], v[72:75], v[16:19]
    ds_read_b64_tr_b16 v[206:207], v229 offset:58368
    ds_read_b64_tr_b16 v[208:209], v230 offset:57344
    v_mfma_f32_16x16x32_bf16 v[20:23], v[136:139], v[76:79], v[20:23]
    ds_read_b64_tr_b16 v[210:211], v230 offset:58368
    v_mfma_f32_16x16x32_bf16 v[24:27], v[140:143], v[72:75], v[24:27]
    ds_read_b64_tr_b16 v[212:213], v231 offset:57344
    ds_read_b64_tr_b16 v[214:215], v231 offset:58368
    v_mfma_f32_16x16x32_bf16 v[28:31], v[140:143], v[76:79], v[28:31]
    ds_read_b64_tr_b16 v[216:217], v232 offset:57344
    v_mfma_f32_16x16x32_bf16 v[32:35], v[144:147], v[72:75], v[32:35]
    ds_read_b64_tr_b16 v[218:219], v232 offset:58368
    ds_read_b64_tr_b16 v[220:221], v233 offset:57344
    v_mfma_f32_16x16x32_bf16 v[36:39], v[144:147], v[76:79], v[36:39]
    ds_read_b64_tr_b16 v[222:223], v233 offset:58368
    v_mfma_f32_16x16x32_bf16 v[40:43], v[148:151], v[72:75], v[40:43]
    v_mfma_f32_16x16x32_bf16 v[44:47], v[148:151], v[76:79], v[44:47]
    v_mfma_f32_16x16x32_bf16 v[48:51], v[152:155], v[72:75], v[48:51]
    v_mfma_f32_16x16x32_bf16 v[52:55], v[152:155], v[76:79], v[52:55]
    v_mfma_f32_16x16x32_bf16 v[56:59], v[156:159], v[72:75], v[56:59]
    v_mfma_f32_16x16x32_bf16 v[60:63], v[156:159], v[76:79], v[60:63]
    s_waitcnt lgkmcnt(0)
    v_mfma_f32_16x16x32_bf16 v[0:3], v[160:163], v[80:83], v[0:3]
    v_mfma_f32_16x16x32_bf16 v[4:7], v[160:163], v[84:87], v[4:7]
    s_barrier
    v_mfma_f32_16x16x32_bf16 v[8:11], v[164:167], v[80:83], v[8:11]
    ds_read_b128 v[64:67], v224 offset:0
    ds_read_b128 v[68:71], v224 offset:2048
    v_mfma_f32_16x16x32_bf16 v[12:15], v[164:167], v[84:87], v[12:15]
    ds_read_b64_tr_b16 v[96:97], v226 offset:0
    v_mfma_f32_16x16x32_bf16 v[16:19], v[168:171], v[80:83], v[16:19]
    ds_read_b64_tr_b16 v[98:99], v226 offset:1024
    ds_read_b64_tr_b16 v[100:101], v227 offset:0
    v_mfma_f32_16x16x32_bf16 v[20:23], v[168:171], v[84:87], v[20:23]
    ds_read_b64_tr_b16 v[102:103], v227 offset:1024
    v_mfma_f32_16x16x32_bf16 v[24:27], v[172:175], v[80:83], v[24:27]
    ds_read_b64_tr_b16 v[104:105], v228 offset:0
    ds_read_b64_tr_b16 v[106:107], v228 offset:1024
    v_mfma_f32_16x16x32_bf16 v[28:31], v[172:175], v[84:87], v[28:31]
    ds_read_b64_tr_b16 v[108:109], v229 offset:0
    v_mfma_f32_16x16x32_bf16 v[32:35], v[176:179], v[80:83], v[32:35]
    ds_read_b64_tr_b16 v[110:111], v229 offset:1024
    ds_read_b64_tr_b16 v[112:113], v230 offset:0
    v_mfma_f32_16x16x32_bf16 v[36:39], v[176:179], v[84:87], v[36:39]
    ds_read_b64_tr_b16 v[114:115], v230 offset:1024
    v_mfma_f32_16x16x32_bf16 v[40:43], v[180:183], v[80:83], v[40:43]
    ds_read_b64_tr_b16 v[116:117], v231 offset:0
    ds_read_b64_tr_b16 v[118:119], v231 offset:1024
    v_mfma_f32_16x16x32_bf16 v[44:47], v[180:183], v[84:87], v[44:47]
    ds_read_b64_tr_b16 v[120:121], v232 offset:0
    v_mfma_f32_16x16x32_bf16 v[48:51], v[184:187], v[80:83], v[48:51]
    ds_read_b64_tr_b16 v[122:123], v232 offset:1024
    ds_read_b64_tr_b16 v[124:125], v233 offset:0
    v_mfma_f32_16x16x32_bf16 v[52:55], v[184:187], v[84:87], v[52:55]
    ds_read_b64_tr_b16 v[126:127], v233 offset:1024
    v_mfma_f32_16x16x32_bf16 v[56:59], v[188:191], v[80:83], v[56:59]
    ds_read_b128 v[72:75], v225 offset:0
    ds_read_b128 v[76:79], v225 offset:2048
    v_mfma_f32_16x16x32_bf16 v[60:63], v[188:191], v[84:87], v[60:63]
    ds_read_b64_tr_b16 v[128:129], v226 offset:8192
    v_mfma_f32_16x16x32_bf16 v[0:3], v[192:195], v[88:91], v[0:3]
    ds_read_b64_tr_b16 v[130:131], v226 offset:9216
    ds_read_b64_tr_b16 v[132:133], v227 offset:8192
    v_mfma_f32_16x16x32_bf16 v[4:7], v[192:195], v[92:95], v[4:7]
    ds_read_b64_tr_b16 v[134:135], v227 offset:9216
    v_mfma_f32_16x16x32_bf16 v[8:11], v[196:199], v[88:91], v[8:11]
    ds_read_b64_tr_b16 v[136:137], v228 offset:8192
    ds_read_b64_tr_b16 v[138:139], v228 offset:9216
    v_mfma_f32_16x16x32_bf16 v[12:15], v[196:199], v[92:95], v[12:15]
    ds_read_b64_tr_b16 v[140:141], v229 offset:8192
    v_mfma_f32_16x16x32_bf16 v[16:19], v[200:203], v[88:91], v[16:19]
    ds_read_b64_tr_b16 v[142:143], v229 offset:9216
    ds_read_b64_tr_b16 v[144:145], v230 offset:8192
    v_mfma_f32_16x16x32_bf16 v[20:23], v[200:203], v[92:95], v[20:23]
    ds_read_b64_tr_b16 v[146:147], v230 offset:9216
    v_mfma_f32_16x16x32_bf16 v[24:27], v[204:207], v[88:91], v[24:27]
    ds_read_b64_tr_b16 v[148:149], v231 offset:8192
    ds_read_b64_tr_b16 v[150:151], v231 offset:9216
    v_mfma_f32_16x16x32_bf16 v[28:31], v[204:207], v[92:95], v[28:31]
    ds_read_b64_tr_b16 v[152:153], v232 offset:8192
    v_mfma_f32_16x16x32_bf16 v[32:35], v[208:211], v[88:91], v[32:35]
    ds_read_b64_tr_b16 v[154:155], v232 offset:9216
    ds_read_b64_tr_b16 v[156:157], v233 offset:8192
    v_mfma_f32_16x16x32_bf16 v[36:39], v[208:211], v[92:95], v[36:39]
    ds_read_b64_tr_b16 v[158:159], v233 offset:9216
    v_mfma_f32_16x16x32_bf16 v[40:43], v[212:215], v[88:91], v[40:43]
    v_mfma_f32_16x16x32_bf16 v[44:47], v[212:215], v[92:95], v[44:47]
    v_mfma_f32_16x16x32_bf16 v[48:51], v[216:219], v[88:91], v[48:51]
    v_mfma_f32_16x16x32_bf16 v[52:55], v[216:219], v[92:95], v[52:55]
    v_mfma_f32_16x16x32_bf16 v[56:59], v[220:223], v[88:91], v[56:59]
    v_mfma_f32_16x16x32_bf16 v[60:63], v[220:223], v[92:95], v[60:63]
    s_waitcnt lgkmcnt(0)
    s_sub_u32 s51, s51, 1
    s_cmp_lg_u32 s51, 0
    s_cbranch_scc1 GLOOP
    s_cmp_lg_u32 s88, 0
    s_cbranch_scc1 TAIL_CONT
    v_and_b32 v245, 15, v252
    v_add_u32 v246, 0, v237
    v_xor_b32 v246, v246, v245
    v_lshlrev_b32 v246, 4, v246
    v_lshl_add_u32 v224, v236, 8, v246
    v_add_u32 v246, 2, v237
    v_xor_b32 v246, v246, v245
    v_lshlrev_b32 v246, 4, v246
    v_lshl_add_u32 v225, v236, 8, v246
    v_add_u32 v246, 4, v237
    v_xor_b32 v246, v246, v245
    v_lshlrev_b32 v246, 4, v246
    v_lshl_add_u32 v226, v236, 8, v246
    v_add_u32 v246, 6, v237
    v_xor_b32 v246, v246, v245
    v_lshlrev_b32 v246, 4, v246
    v_lshl_add_u32 v227, v236, 8, v246
    v_add_u32 v246, 8, v237
    v_xor_b32 v246, v246, v245
    v_lshlrev_b32 v246, 4, v246
    v_lshl_add_u32 v228, v236, 8, v246
    v_add_u32 v246, 10, v237
    v_xor_b32 v246, v246, v245
    v_lshlrev_b32 v246, 4, v246
    v_lshl_add_u32 v229, v236, 8, v246
    v_add_u32 v246, 12, v237
    v_xor_b32 v246, v246, v245
    v_lshlrev_b32 v246, 4, v246
    v_lshl_add_u32 v230, v236, 8, v246
    v_add_u32 v246, 14, v237
    v_xor_b32 v246, v246, v245
    v_lshlrev_b32 v246, 4, v246
    v_lshl_add_u32 v231, v236, 8, v246
    v_lshl_add_u32 v246, v237, 2, v238
    v_lshl_add_u32 v246, v246, 8, v239
    v_xor_b32 v244, 0, v238
    v_lshl_add_u32 v244, v244, 6, v246
    v_add_u32 v240, 65536, v244
    v_xor_b32 v244, 1, v238
    v_lshl_add_u32 v244, v244, 6, v246
    v_add_u32 v241, 65536, v244
    v_xor_b32 v244, 2, v238
    v_lshl_add_u32 v244, v244, 6, v246
    v_add_u32 v242, 65536, v244
    v_xor_b32 v244, 3, v238
    v_lshl_add_u32 v244, v244, 6, v246
    v_add_u32 v243, 65536, v244
    v_mov_b32 v232, v224
    v_mov_b32 v233, v225
    v_mov_b32 v234, v226
    v_mov_b32 v235, v227
    v_mov_b32 v236, v228
    v_mov_b32 v237, v229
    v_mov_b32 v238, v230
    v_mov_b32 v239, v231
    s_mov_b32 s44, 0x3e0293ee
    ds_read_b128 v[176:179], v232 offset:0
    ds_read_b128 v[180:183], v233 offset:0
    ds_read_b128 v[184:187], v234 offset:0
    ds_read_b128 v[188:191], v235 offset:0
    ds_read_b128 v[192:195], v236 offset:0
    ds_read_b128 v[196:199], v237 offset:0
    v_mul_f32 v0, s44, v0
    v_mul_f32 v1, s44, v1
    v_mul_f32 v2, s44, v2
    v_mul_f32 v3, s44, v3
    v_mul_f32 v4, s44, v4
    v_mul_f32 v5, s44, v5
    v_mul_f32 v6, s44, v6
    v_mul_f32 v7, s44, v7
    v_cvt_pk_bf16_f32 v64, v0, v1
    v_cvt_pk_bf16_f32 v65, v2, v3
    v_cvt_pk_bf16_f32 v66, v4, v5
    v_cvt_pk_bf16_f32 v67, v6, v7
    v_mul_f32 v8, s44, v8
    v_mul_f32 v9, s44, v9
    v_mul_f32 v10, s44, v10
    v_mul_f32 v11, s44, v11
    v_mul_f32 v12, s44, v12
    v_mul_f32 v13, s44, v13
    v_mul_f32 v14, s44, v14
    v_mul_f32 v15, s44, v15
    v_cvt_pk_bf16_f32 v68, v8, v9
    v_cvt_pk_bf16_f32 v69, v10, v11
    v_cvt_pk_bf16_f32 v70, v12, v13
    v_cvt_pk_bf16_f32 v71, v14, v15
    v_mul_f32 v16, s44, v16
    v_mul_f32 v17, s44, v17
    v_mul_f32 v18, s44, v18
    v_mul_f32 v19, s44, v19
    v_mul_f32 v20, s44, v20
    v_mul_f32 v21, s44, v21
    v_mul_f32 v22, s44, v22
    v_mul_f32 v23, s44, v23
    v_cvt_pk_bf16_f32 v72, v16, v17
    v_cvt_pk_bf16_f32 v73, v18, v19
    v_cvt_pk_bf16_f32 v74, v20, v21
    v_cvt_pk_bf16_f32 v75, v22, v23
    v_mul_f32 v24, s44, v24
    v_mul_f32 v25, s44, v25
    v_mul_f32 v26, s44, v26
    v_mul_f32 v27, s44, v27
    v_mul_f32 v28, s44, v28
    v_mul_f32 v29, s44, v29
    v_mul_f32 v30, s44, v30
    v_mul_f32 v31, s44, v31
    v_cvt_pk_bf16_f32 v76, v24, v25
    v_cvt_pk_bf16_f32 v77, v26, v27
    v_cvt_pk_bf16_f32 v78, v28, v29
    v_cvt_pk_bf16_f32 v79, v30, v31
    v_mul_f32 v32, s44, v32
    v_mul_f32 v33, s44, v33
    v_mul_f32 v34, s44, v34
    v_mul_f32 v35, s44, v35
    v_mul_f32 v36, s44, v36
    v_mul_f32 v37, s44, v37
    v_mul_f32 v38, s44, v38
    v_mul_f32 v39, s44, v39
    v_cvt_pk_bf16_f32 v80, v32, v33
    v_cvt_pk_bf16_f32 v81, v34, v35
    v_cvt_pk_bf16_f32 v82, v36, v37
    v_cvt_pk_bf16_f32 v83, v38, v39
    v_mul_f32 v40, s44, v40
    v_mul_f32 v41, s44, v41
    v_mul_f32 v42, s44, v42
    v_mul_f32 v43, s44, v43
    v_mul_f32 v44, s44, v44
    v_mul_f32 v45, s44, v45
    v_mul_f32 v46, s44, v46
    v_mul_f32 v47, s44, v47
    v_cvt_pk_bf16_f32 v84, v40, v41
    v_cvt_pk_bf16_f32 v85, v42, v43
    v_cvt_pk_bf16_f32 v86, v44, v45
    v_cvt_pk_bf16_f32 v87, v46, v47
    v_mul_f32 v48, s44, v48
    v_mul_f32 v49, s44, v49
    v_mul_f32 v50, s44, v50
    v_mul_f32 v51, s44, v51
    v_mul_f32 v52, s44, v52
    v_mul_f32 v53, s44, v53
    v_mul_f32 v54, s44, v54
    v_mul_f32 v55, s44, v55
    v_cvt_pk_bf16_f32 v88, v48, v49
    v_cvt_pk_bf16_f32 v89, v50, v51
    v_cvt_pk_bf16_f32 v90, v52, v53
    v_cvt_pk_bf16_f32 v91, v54, v55
    v_mul_f32 v56, s44, v56
    v_mul_f32 v57, s44, v57
    v_mul_f32 v58, s44, v58
    v_mul_f32 v59, s44, v59
    v_mul_f32 v60, s44, v60
    v_mul_f32 v61, s44, v61
    v_mul_f32 v62, s44, v62
    v_mul_f32 v63, s44, v63
    v_cvt_pk_bf16_f32 v92, v56, v57
    v_cvt_pk_bf16_f32 v93, v58, v59
    v_cvt_pk_bf16_f32 v94, v60, v61
    v_cvt_pk_bf16_f32 v95, v62, v63
    v_permlane16_swap_b32 v64, v66
    v_permlane16_swap_b32 v65, v67
    v_permlane16_swap_b32 v68, v70
    v_permlane16_swap_b32 v69, v71
    v_permlane16_swap_b32 v72, v74
    v_permlane16_swap_b32 v73, v75
    v_permlane16_swap_b32 v76, v78
    v_permlane16_swap_b32 v77, v79
    v_permlane16_swap_b32 v80, v82
    v_permlane16_swap_b32 v81, v83
    v_permlane16_swap_b32 v84, v86
    v_permlane16_swap_b32 v85, v87
    v_permlane16_swap_b32 v88, v90
    v_permlane16_swap_b32 v89, v91
    v_permlane16_swap_b32 v92, v94
    v_permlane16_swap_b32 v93, v95
    s_waitcnt lgkmcnt(4)
    v_mfma_f32_32x32x16_bf16 v[96:111], v[176:179], v[64:67], 0
    ds_read_b128 v[176:179], v238 offset:0
    v_mov_b32 v0, 0
    v_mov_b32 v1, 0
    v_mov_b32 v2, 0
    v_mov_b32 v3, 0
    v_mfma_f32_32x32x16_bf16 v[96:111], v[180:183], v[68:71], v[96:111]
    ds_read_b128 v[180:183], v239 offset:0
    v_mov_b32 v4, 0
    v_mov_b32 v5, 0
    v_mov_b32 v6, 0
    v_mov_b32 v7, 0
    s_waitcnt lgkmcnt(4)
    v_mfma_f32_32x32x16_bf16 v[96:111], v[184:187], v[72:75], v[96:111]
    ds_read_b128 v[184:187], v232 offset:8192
    v_mov_b32 v8, 0
    v_mov_b32 v9, 0
    v_mov_b32 v10, 0
    v_mov_b32 v11, 0
    v_mfma_f32_32x32x16_bf16 v[96:111], v[188:191], v[76:79], v[96:111]
    ds_read_b128 v[188:191], v233 offset:8192
    v_mov_b32 v12, 0
    v_mov_b32 v13, 0
    v_mov_b32 v14, 0
    v_mov_b32 v15, 0
    s_waitcnt lgkmcnt(4)
    v_mfma_f32_32x32x16_bf16 v[96:111], v[192:195], v[80:83], v[96:111]
    ds_read_b128 v[192:195], v234 offset:8192
    v_mov_b32 v16, 0
    v_mov_b32 v17, 0
    v_mov_b32 v18, 0
    v_mov_b32 v19, 0
    v_mfma_f32_32x32x16_bf16 v[96:111], v[196:199], v[84:87], v[96:111]
    ds_read_b128 v[196:199], v235 offset:8192
    v_mov_b32 v20, 0
    v_mov_b32 v21, 0
    v_mov_b32 v22, 0
    v_mov_b32 v23, 0
    s_waitcnt lgkmcnt(4)
    v_mfma_f32_32x32x16_bf16 v[96:111], v[176:179], v[88:91], v[96:111]
    ds_read_b128 v[176:179], v236 offset:8192
    v_mov_b32 v24, 0
    v_mov_b32 v25, 0
    v_mov_b32 v26, 0
    v_mov_b32 v27, 0
    v_mfma_f32_32x32x16_bf16 v[96:111], v[180:183], v[92:95], v[96:111]
    ds_read_b128 v[180:183], v237 offset:8192
    v_mov_b32 v28, 0
    v_mov_b32 v29, 0
    v_mov_b32 v30, 0
    v_mov_b32 v31, 0
    s_waitcnt lgkmcnt(4)
    v_mfma_f32_32x32x16_bf16 v[112:127], v[184:187], v[64:67], 0
    ds_read_b128 v[184:187], v238 offset:8192
    v_mov_b32 v32, 0
    v_mov_b32 v33, 0
    v_mov_b32 v34, 0
    v_mov_b32 v35, 0
    v_mfma_f32_32x32x16_bf16 v[112:127], v[188:191], v[68:71], v[112:127]
    ds_read_b128 v[188:191], v239 offset:8192
    v_mov_b32 v36, 0
    v_mov_b32 v37, 0
    v_mov_b32 v38, 0
    v_mov_b32 v39, 0
    s_waitcnt lgkmcnt(4)
    v_mfma_f32_32x32x16_bf16 v[112:127], v[192:195], v[72:75], v[112:127]
    v_mov_b32 v40, 0
    v_mov_b32 v41, 0
    v_mov_b32 v42, 0
    v_mov_b32 v43, 0
    v_mfma_f32_32x32x16_bf16 v[112:127], v[196:199], v[76:79], v[112:127]
    v_mov_b32 v44, 0
    v_mov_b32 v45, 0
    v_mov_b32 v46, 0
    v_mov_b32 v47, 0
    s_waitcnt lgkmcnt(2)
    v_mfma_f32_32x32x16_bf16 v[112:127], v[176:179], v[80:83], v[112:127]
    v_mov_b32 v48, 0
    v_mov_b32 v49, 0
    v_mov_b32 v50, 0
    v_mov_b32 v51, 0
    v_mfma_f32_32x32x16_bf16 v[112:127], v[180:183], v[84:87], v[112:127]
    v_mov_b32 v52, 0
    v_mov_b32 v53, 0
    v_mov_b32 v54, 0
    v_mov_b32 v55, 0
    s_waitcnt lgkmcnt(0)
    v_mfma_f32_32x32x16_bf16 v[112:127], v[184:187], v[88:91], v[112:127]
    v_mov_b32 v56, 0
    v_mov_b32 v57, 0
    v_mov_b32 v58, 0
    v_mov_b32 v59, 0
    v_mfma_f32_32x32x16_bf16 v[112:127], v[188:191], v[92:95], v[112:127]
    v_mov_b32 v60, 0
    v_mov_b32 v61, 0
    v_mov_b32 v62, 0
    v_mov_b32 v63, 0
    v_mov_b32 v248, 0
    v_mov_b32 v249, 0
    v_max3_f32 v252, v96, v97, v98
    s_nop 4
    v_max3_f32 v253, v112, v113, v114
    v_max3_f32 v252, v252, v99, v100
    v_max3_f32 v253, v253, v115, v116
    v_max3_f32 v252, v252, v101, v102
    v_max3_f32 v253, v253, v117, v118
    v_max3_f32 v252, v252, v103, v104
    v_max3_f32 v253, v253, v119, v120
    v_max3_f32 v252, v252, v105, v106
    v_max3_f32 v253, v253, v121, v122
    v_max3_f32 v252, v252, v107, v108
    v_max3_f32 v253, v253, v123, v124
    v_max3_f32 v252, v252, v109, v110
    v_max3_f32 v253, v253, v125, v126
    v_max3_f32 v252, v252, v111, v127
    v_max_f32 v252, v252, v253
    v_mov_b32 v253, v252
    s_nop 1
    v_permlane32_swap_b32 v252, v253
    v_max_f32 v252, v252, v253
    v_sub_f32 v160, 0, v252
    v_sub_f32 v161, 0, v252
    v_sub_f32 v162, 0, v252
    v_sub_f32 v163, 0, v252
    v_sub_f32 v164, 0, v252
    v_sub_f32 v165, 0, v252
    v_sub_f32 v166, 0, v252
    v_sub_f32 v167, 0, v252
    v_sub_f32 v168, 0, v252
    v_sub_f32 v169, 0, v252
    v_sub_f32 v170, 0, v252
    v_sub_f32 v171, 0, v252
    v_sub_f32 v172, 0, v252
    v_sub_f32 v173, 0, v252
    v_sub_f32 v174, 0, v252
    v_sub_f32 v175, 0, v252
    v_sub_f32 v96, v96, v252
    v_sub_f32 v97, v97, v252
    v_sub_f32 v98, v98, v252
    v_sub_f32 v99, v99, v252
    v_sub_f32 v100, v100, v252
    v_sub_f32 v101, v101, v252
    v_sub_f32 v102, v102, v252
    v_sub_f32 v103, v103, v252
    v_sub_f32 v104, v104, v252
    v_sub_f32 v105, v105, v252
    v_sub_f32 v106, v106, v252
    v_sub_f32 v107, v107, v252
    v_sub_f32 v108, v108, v252
    v_sub_f32 v109, v109, v252
    v_sub_f32 v110, v110, v252
    v_sub_f32 v111, v111, v252
    v_sub_f32 v112, v112, v252
    v_sub_f32 v113, v113, v252
    v_sub_f32 v114, v114, v252
    v_sub_f32 v115, v115, v252
    v_sub_f32 v116, v116, v252
    v_sub_f32 v117, v117, v252
    v_sub_f32 v118, v118, v252
    v_sub_f32 v119, v119, v252
    v_sub_f32 v120, v120, v252
    v_sub_f32 v121, v121, v252
    v_sub_f32 v122, v122, v252
    v_sub_f32 v123, v123, v252
    v_sub_f32 v124, v124, v252
    v_sub_f32 v125, v125, v252
    v_sub_f32 v126, v126, v252
    v_sub_f32 v127, v127, v252
    v_mov_b32 v152, 0
    v_mov_b32 v153, 0
    v_mov_b32 v154, 0
    v_mov_b32 v155, 0
    v_mov_b32 v216, 0
    v_mov_b32 v217, 0
    v_mov_b32 v218, 0
    v_mov_b32 v219, 0
    v_mov_b32 v220, 0
    v_mov_b32 v221, 0
    v_mov_b32 v222, 0
    v_mov_b32 v223, 0
    v_mov_b32 v224, 0
    v_mov_b32 v225, 0
    v_mov_b32 v226, 0
    v_mov_b32 v227, 0
    v_mov_b32 v228, 0
    v_mov_b32 v229, 0
    v_mov_b32 v230, 0
    v_mov_b32 v231, 0
    s_waitcnt lgkmcnt(0)
    s_mov_b32 s51, 4
K1_LOOP:
    s_waitcnt lgkmcnt(4)
    v_mfma_f32_32x32x16_bf16 v[0:15], v[216:219], v[152:155], v[0:15]
    v_max3_f32 v252, v96, v97, v98
    v_max3_f32 v253, v112, v113, v114
    v_max3_f32 v252, v252, v99, v100
    v_max3_f32 v253, v253, v115, v116
    s_waitcnt lgkmcnt(0)
    s_barrier
    ds_read_b128 v[176:179], v232 offset:16384
    ds_read_b128 v[180:183], v233 offset:16384
    ds_read_b128 v[184:187], v234 offset:16384
    v_mfma_f32_32x32x16_bf16 v[16:31], v[220:223], v[152:155], v[16:31]
    ds_read_b128 v[188:191], v235 offset:16384
    ds_read_b128 v[192:195], v236 offset:16384
    ds_read_b128 v[196:199], v237 offset:16384
    v_max3_f32 v252, v252, v101, v102
    v_max3_f32 v253, v253, v117, v118
    v_max3_f32 v252, v252, v103, v104
    v_max3_f32 v253, v253, v119, v120
    v_max3_f32 v252, v252, v105, v106
    v_mfma_f32_32x32x16_bf16 v[32:47], v[224:227], v[152:155], v[32:47]
    v_max3_f32 v253, v253, v121, v122
    v_max3_f32 v252, v252, v107, v108
    v_max3_f32 v253, v253, v123, v124
    v_max3_f32 v252, v252, v109, v110
    v_max3_f32 v253, v253, v125, v126
    v_max3_f32 v252, v252, v111, v127
    v_max_f32 v252, v252, v253
    v_cmp_lt_f32 vcc, 0x41000000, v252
    v_mfma_f32_32x32x16_bf16 v[48:63], v[228:231], v[152:155], v[48:63]
    s_nop 0
    s_cbranch_vccnz RARE_L0
BACK_L0:
    v_exp_f32 v96, v96
    v_exp_f32 v97, v97
    s_waitcnt lgkmcnt(4)
    v_mfma_f32_32x32x16_bf16 v[128:143], v[176:179], v[64:67], v[160:175]
    ds_read_b128 v[176:179], v238 offset:16384
    v_add_f32 v248, v248, v96
    v_exp_f32 v98, v98
    v_add_f32 v248, v248, v97
    v_exp_f32 v99, v99
    v_mfma_f32_32x32x16_bf16 v[128:143], v[180:183], v[68:71], v[128:143]
    ds_read_b128 v[180:183], v239 offset:16384
    v_add_f32 v248, v248, v98
    v_cvt_pk_bf16_f32 v96, v96, v97
    v_exp_f32 v100, v100
    v_add_f32 v248, v248, v99
    s_waitcnt lgkmcnt(4)
    v_mfma_f32_32x32x16_bf16 v[128:143], v[184:187], v[72:75], v[128:143]
    ds_read_b128 v[184:187], v232 offset:24576
    v_exp_f32 v101, v101
    v_add_f32 v248, v248, v100
    v_cvt_pk_bf16_f32 v97, v98, v99
    v_exp_f32 v102, v102
    v_mfma_f32_32x32x16_bf16 v[128:143], v[188:191], v[76:79], v[128:143]
    ds_read_b128 v[188:191], v233 offset:24576
    v_add_f32 v248, v248, v101
    v_exp_f32 v103, v103
    v_add_f32 v248, v248, v102
    s_waitcnt lgkmcnt(4)
    v_mfma_f32_32x32x16_bf16 v[128:143], v[192:195], v[80:83], v[128:143]
    ds_read_b128 v[192:195], v234 offset:24576
    v_cvt_pk_bf16_f32 v98, v100, v101
    v_add_f32 v248, v248, v103
    v_cvt_pk_bf16_f32 v99, v102, v103
    v_exp_f32 v104, v104
    v_exp_f32 v105, v105
    v_mfma_f32_32x32x16_bf16 v[128:143], v[196:199], v[84:87], v[128:143]
    ds_read_b128 v[196:199], v235 offset:24576
    v_add_f32 v248, v248, v104
    v_exp_f32 v106, v106
    v_add_f32 v248, v248, v105
    s_waitcnt lgkmcnt(4)
    v_mfma_f32_32x32x16_bf16 v[128:143], v[176:179], v[88:91], v[128:143]
    ds_read_b128 v[176:179], v236 offset:24576
    v_exp_f32 v107, v107
    v_add_f32 v248, v248, v106
    v_cvt_pk_bf16_f32 v104, v104, v105
    v_exp_f32 v108, v108
    v_mfma_f32_32x32x16_bf16 v[128:143], v[180:183], v[92:95], v[128:143]
    ds_read_b128 v[180:183], v237 offset:24576
    v_add_f32 v248, v248, v107
    v_exp_f32 v109, v109
    v_add_f32 v248, v248, v108
    s_waitcnt lgkmcnt(4)
    v_mfma_f32_32x32x16_bf16 v[144:159], v[184:187], v[64:67], v[160:175]
    ds_read_b128 v[184:187], v238 offset:24576
    v_cvt_pk_bf16_f32 v105, v106, v107
    v_exp_f32 v110, v110
    v_add_f32 v248, v248, v109
    v_exp_f32 v111, v111
    v_mfma_f32_32x32x16_bf16 v[144:159], v[188:191], v[68:71], v[144:159]
    ds_read_b128 v[188:191], v239 offset:24576
    v_add_f32 v248, v248, v110
    v_cvt_pk_bf16_f32 v106, v108, v109
    v_add_f32 v248, v248, v111
    v_cvt_pk_bf16_f32 v107, v110, v111
    v_exp_f32 v112, v112
    s_waitcnt lgkmcnt(4)
    v_mfma_f32_32x32x16_bf16 v[144:159], v[192:195], v[72:75], v[144:159]
    v_exp_f32 v113, v113
    v_add_f32 v248, v248, v112
    v_exp_f32 v114, v114
    v_mfma_f32_32x32x16_bf16 v[144:159], v[196:199], v[76:79], v[144:159]
    v_add_f32 v248, v248, v113
    v_exp_f32 v115, v115
    v_add_f32 v248, v248, v114
    s_waitcnt lgkmcnt(2)
    v_mfma_f32_32x32x16_bf16 v[144:159], v[176:179], v[80:83], v[144:159]
    v_cvt_pk_bf16_f32 v112, v112, v113
    ds_read_b64_tr_b16 v[200:201], v240 offset:0
    ds_read_b64_tr_b16 v[202:203], v240 offset:2048
    ds_read_b64_tr_b16 v[204:205], v241 offset:0
    ds_read_b64_tr_b16 v[206:207], v241 offset:2048
    ds_read_b64_tr_b16 v[208:209], v242 offset:0
    v_mfma_f32_32x32x16_bf16 v[144:159], v[180:183], v[84:87], v[144:159]
    ds_read_b64_tr_b16 v[210:211], v242 offset:2048
    ds_read_b64_tr_b16 v[212:213], v243 offset:0
    ds_read_b64_tr_b16 v[214:215], v243 offset:2048
    ds_read_b64_tr_b16 v[216:217], v240 offset:4096
    ds_read_b64_tr_b16 v[218:219], v240 offset:6144
    s_waitcnt lgkmcnt(10)
    v_mfma_f32_32x32x16_bf16 v[144:159], v[184:187], v[88:91], v[144:159]
    ds_read_b64_tr_b16 v[220:221], v241 offset:4096
    ds_read_b64_tr_b16 v[222:223], v241 offset:6144
    ds_read_b64_tr_b16 v[224:225], v242 offset:4096
    ds_read_b64_tr_b16 v[226:227], v242 offset:6144
    ds_read_b64_tr_b16 v[228:229], v243 offset:4096
    v_mfma_f32_32x32x16_bf16 v[144:159], v[188:191], v[92:95], v[144:159]
    ds_read_b64_tr_b16 v[230:231], v243 offset:6144
    s_waitcnt lgkmcnt(12)
    v_mfma_f32_32x32x16_bf16 v[0:15], v[200:203], v[96:99], v[0:15]
    ds_read_b64_tr_b16 v[200:201], v240 offset:8192
    ds_read_b64_tr_b16 v[202:203], v240 offset:10240
    v_exp_f32 v116, v116
    v_add_f32 v248, v248, v115
    v_exp_f32 v117, v117
    v_mfma_f32_32x32x16_bf16 v[16:31], v[204:207], v[96:99], v[16:31]
    ds_read_b64_tr_b16 v[204:205], v241 offset:8192
    ds_read_b64_tr_b16 v[206:207], v241 offset:10240
    v_add_f32 v248, v248, v116
    v_cvt_pk_bf16_f32 v113, v114, v115
    v_exp_f32 v118, v118
    s_waitcnt lgkmcnt(12)
    v_mfma_f32_32x32x16_bf16 v[32:47], v[208:211], v[96:99], v[32:47]
    ds_read_b64_tr_b16 v[208:209], v242 offset:8192
    ds_read_b64_tr_b16 v[210:211], v242 offset:10240
    v_add_f32 v248, v248, v117
    v_exp_f32 v119, v119
    v_mfma_f32_32x32x16_bf16 v[48:63], v[212:215], v[96:99], v[48:63]
    ds_read_b64_tr_b16 v[212:213], v243 offset:8192
    ds_read_b64_tr_b16 v[214:215], v243 offset:10240
    v_add_f32 v248, v248, v118
    v_cvt_pk_bf16_f32 v114, v116, v117
    v_add_f32 v248, v248, v119
    v_cvt_pk_bf16_f32 v115, v118, v119
    s_waitcnt lgkmcnt(12)
    v_mfma_f32_32x32x16_bf16 v[0:15], v[216:219], v[104:107], v[0:15]
    ds_read_b64_tr_b16 v[216:217], v240 offset:12288
    ds_read_b64_tr_b16 v[218:219], v240 offset:14336
    v_exp_f32 v120, v120
    v_exp_f32 v121, v121
    v_mfma_f32_32x32x16_bf16 v[16:31], v[220:223], v[104:107], v[16:31]
    ds_read_b64_tr_b16 v[220:221], v241 offset:12288
    ds_read_b64_tr_b16 v[222:223], v241 offset:14336
    v_add_f32 v248, v248, v120
    v_exp_f32 v122, v122
    v_add_f32 v248, v248, v121
    s_waitcnt lgkmcnt(12)
    v_mfma_f32_32x32x16_bf16 v[32:47], v[224:227], v[104:107], v[32:47]
    ds_read_b64_tr_b16 v[224:225], v242 offset:12288
    ds_read_b64_tr_b16 v[226:227], v242 offset:14336
    v_exp_f32 v123, v123
    v_add_f32 v248, v248, v122
    v_cvt_pk_bf16_f32 v120, v120, v121
    v_mfma_f32_32x32x16_bf16 v[48:63], v[228:231], v[104:107], v[48:63]
    ds_read_b64_tr_b16 v[228:229], v243 offset:12288
    ds_read_b64_tr_b16 v[230:231], v243 offset:14336
    v_exp_f32 v124, v124
    v_add_f32 v248, v248, v123
    s_waitcnt lgkmcnt(12)
    v_mfma_f32_32x32x16_bf16 v[0:15], v[200:203], v[112:115], v[0:15]
    v_exp_f32 v125, v125
    v_add_f32 v248, v248, v124
    v_cvt_pk_bf16_f32 v121, v122, v123
    v_mfma_f32_32x32x16_bf16 v[16:31], v[204:207], v[112:115], v[16:31]
    v_exp_f32 v126, v126
    v_add_f32 v248, v248, v125
    s_waitcnt lgkmcnt(8)
    v_mfma_f32_32x32x16_bf16 v[32:47], v[208:211], v[112:115], v[32:47]
    v_exp_f32 v127, v127
    v_add_f32 v248, v248, v126
    v_mfma_f32_32x32x16_bf16 v[48:63], v[212:215], v[112:115], v[48:63]
    v_cvt_pk_bf16_f32 v122, v124, v125
    v_add_f32 v248, v248, v127
    v_cvt_pk_bf16_f32 v123, v126, v127
    s_waitcnt lgkmcnt(4)
    s_nop 0
    v_mfma_f32_32x32x16_bf16 v[0:15], v[216:219], v[120:123], v[0:15]
    v_max3_f32 v252, v128, v129, v130
    v_max3_f32 v253, v144, v145, v146
    v_max3_f32 v252, v252, v131, v132
    v_max3_f32 v253, v253, v147, v148
    s_waitcnt lgkmcnt(0)
    s_barrier
    ds_read_b128 v[176:179], v232 offset:32768
    ds_read_b128 v[180:183], v233 offset:32768
    ds_read_b128 v[184:187], v234 offset:32768
    v_mfma_f32_32x32x16_bf16 v[16:31], v[220:223], v[120:123], v[16:31]
    ds_read_b128 v[188:191], v235 offset:32768
    ds_read_b128 v[192:195], v236 offset:32768
    ds_read_b128 v[196:199], v237 offset:32768
    v_max3_f32 v252, v252, v133, v134
    v_max3_f32 v253, v253, v149, v150
    v_max3_f32 v252, v252, v135, v136
    v_max3_f32 v253, v253, v151, v152
    v_max3_f32 v252, v252, v137, v138
    v_mfma_f32_32x32x16_bf16 v[32:47], v[224:227], v[120:123], v[32:47]
    v_max3_f32 v253, v253, v153, v154
    v_max3_f32 v252, v252, v139, v140
    v_max3_f32 v253, v253, v155, v156
    v_max3_f32 v252, v252, v141, v142
    v_max3_f32 v253, v253, v157, v158
    v_max3_f32 v252, v252, v143, v159
    v_max_f32 v252, v252, v253
    v_cmp_lt_f32 vcc, 0x41000000, v252
    v_mfma_f32_32x32x16_bf16 v[48:63], v[228:231], v[120:123], v[48:63]
    s_nop 0
    s_cbranch_vccnz RARE_L1
BACK_L1:
    v_exp_f32 v128, v128
    v_exp_f32 v129, v129
    s_waitcnt lgkmcnt(4)
    v_mfma_f32_32x32x16_bf16 v[96:111], v[176:179], v[64:67], v[160:175]
    ds_read_b128 v[176:179], v238 offset:32768
    v_add_f32 v248, v248, v128
    v_exp_f32 v130, v130
    v_add_f32 v248, v248, v129
    v_exp_f32 v131, v131
    v_mfma_f32_32x32x16_bf16 v[96:111], v[180:183], v[68:71], v[96:111]
    ds_read_b128 v[180:183], v239 offset:32768
    v_add_f32 v248, v248, v130
    v_cvt_pk_bf16_f32 v128, v128, v129
    v_exp_f32 v132, v132
    v_add_f32 v248, v248, v131
    s_waitcnt lgkmcnt(4)
    v_mfma_f32_32x32x16_bf16 v[96:111], v[184:187], v[72:75], v[96:111]
    ds_read_b128 v[184:187], v232 offset:40960
    v_exp_f32 v133, v133
    v_add_f32 v248, v248, v132
    v_cvt_pk_bf16_f32 v129, v130, v131
    v_exp_f32 v134, v134
    v_mfma_f32_32x32x16_bf16 v[96:111], v[188:191], v[76:79], v[96:111]
    ds_read_b128 v[188:191], v233 offset:40960
    v_add_f32 v248, v248, v133
    v_exp_f32 v135, v135
    v_add_f32 v248, v248, v134
    s_waitcnt lgkmcnt(4)
    v_mfma_f32_32x32x16_bf16 v[96:111], v[192:195], v[80:83], v[96:111]
    ds_read_b128 v[192:195], v234 offset:40960
    v_cvt_pk_bf16_f32 v130, v132, v133
    v_add_f32 v248, v248, v135
    v_cvt_pk_bf16_f32 v131, v134, v135
    v_exp_f32 v136, v136
    v_exp_f32 v137, v137
    v_mfma_f32_32x32x16_bf16 v[96:111], v[196:199], v[84:87], v[96:111]
    ds_read_b128 v[196:199], v235 offset:40960
    v_add_f32 v248, v248, v136
    v_exp_f32 v138, v138
    v_add_f32 v248, v248, v137
    s_waitcnt lgkmcnt(4)
    v_mfma_f32_32x32x16_bf16 v[96:111], v[176:179], v[88:91], v[96:111]
    ds_read_b128 v[176:179], v236 offset:40960
    v_exp_f32 v139, v139
    v_add_f32 v248, v248, v138
    v_cvt_pk_bf16_f32 v136, v136, v137
    v_exp_f32 v140, v140
    v_mfma_f32_32x32x16_bf16 v[96:111], v[180:183], v[92:95], v[96:111]
    ds_read_b128 v[180:183], v237 offset:40960
    v_add_f32 v248, v248, v139
    v_exp_f32 v141, v141
    v_add_f32 v248, v248, v140
    s_waitcnt lgkmcnt(4)
    v_mfma_f32_32x32x16_bf16 v[112:127], v[184:187], v[64:67], v[160:175]
    ds_read_b128 v[184:187], v238 offset:40960
    v_cvt_pk_bf16_f32 v137, v138, v139
    v_exp_f32 v142, v142
    v_add_f32 v248, v248, v141
    v_exp_f32 v143, v143
    v_mfma_f32_32x32x16_bf16 v[112:127], v[188:191], v[68:71], v[112:127]
    ds_read_b128 v[188:191], v239 offset:40960
    v_add_f32 v248, v248, v142
    v_cvt_pk_bf16_f32 v138, v140, v141
    v_add_f32 v248, v248, v143
    v_cvt_pk_bf16_f32 v139, v142, v143
    v_exp_f32 v144, v144
    s_waitcnt lgkmcnt(4)
    v_mfma_f32_32x32x16_bf16 v[112:127], v[192:195], v[72:75], v[112:127]
    v_exp_f32 v145, v145
    v_add_f32 v248, v248, v144
    v_exp_f32 v146, v146
    v_mfma_f32_32x32x16_bf16 v[112:127], v[196:199], v[76:79], v[112:127]
    v_add_f32 v248, v248, v145
    v_exp_f32 v147, v147
    v_add_f32 v248, v248, v146
    s_waitcnt lgkmcnt(2)
    v_mfma_f32_32x32x16_bf16 v[112:127], v[176:179], v[80:83], v[112:127]
    v_cvt_pk_bf16_f32 v144, v144, v145
    ds_read_b64_tr_b16 v[200:201], v240 offset:16384
    ds_read_b64_tr_b16 v[202:203], v240 offset:18432
    ds_read_b64_tr_b16 v[204:205], v241 offset:16384
    ds_read_b64_tr_b16 v[206:207], v241 offset:18432
    ds_read_b64_tr_b16 v[208:209], v242 offset:16384
    v_mfma_f32_32x32x16_bf16 v[112:127], v[180:183], v[84:87], v[112:127]
    ds_read_b64_tr_b16 v[210:211], v242 offset:18432
    ds_read_b64_tr_b16 v[212:213], v243 offset:16384
    ds_read_b64_tr_b16 v[214:215], v243 offset:18432
    ds_read_b64_tr_b16 v[216:217], v240 offset:20480
    ds_read_b64_tr_b16 v[218:219], v240 offset:22528
    s_waitcnt lgkmcnt(10)
    v_mfma_f32_32x32x16_bf16 v[112:127], v[184:187], v[88:91], v[112:127]
    ds_read_b64_tr_b16 v[220:221], v241 offset:20480
    ds_read_b64_tr_b16 v[222:223], v241 offset:22528
    ds_read_b64_tr_b16 v[224:225], v242 offset:20480
    ds_read_b64_tr_b16 v[226:227], v242 offset:22528
    ds_read_b64_tr_b16 v[228:229], v243 offset:20480
    v_mfma_f32_32x32x16_bf16 v[112:127], v[188:191], v[92:95], v[112:127]
    ds_read_b64_tr_b16 v[230:231], v243 offset:22528
    s_waitcnt lgkmcnt(12)
    v_mfma_f32_32x32x16_bf16 v[0:15], v[200:203], v[128:131], v[0:15]
    ds_read_b64_tr_b16 v[200:201], v240 offset:24576
    ds_read_b64_tr_b16 v[202:203], v240 offset:26624
    v_exp_f32 v148, v148
    v_add_f32 v248, v248, v147
    v_exp_f32 v149, v149
    v_mfma_f32_32x32x16_bf16 v[16:31], v[204:207], v[128:131], v[16:31]
    ds_read_b64_tr_b16 v[204:205], v241 offset:24576
    ds_read_b64_tr_b16 v[206:207], v241 offset:26624
    v_add_f32 v248, v248, v148
    v_cvt_pk_bf16_f32 v145, v146, v147
    v_exp_f32 v150, v150
    s_waitcnt lgkmcnt(12)
    v_mfma_f32_32x32x16_bf16 v[32:47], v[208:211], v[128:131], v[32:47]
    ds_read_b64_tr_b16 v[208:209], v242 offset:24576
    ds_read_b64_tr_b16 v[210:211], v242 offset:26624
    v_add_f32 v248, v248, v149
    v_exp_f32 v151, v151
    v_mfma_f32_32x32x16_bf16 v[48:63], v[212:215], v[128:131], v[48:63]
    ds_read_b64_tr_b16 v[212:213], v243 offset:24576
    ds_read_b64_tr_b16 v[214:215], v243 offset:26624
    v_add_f32 v248, v248, v150
    v_cvt_pk_bf16_f32 v146, v148, v149
    v_add_f32 v248, v248, v151
    v_cvt_pk_bf16_f32 v147, v150, v151
    s_waitcnt lgkmcnt(12)
    v_mfma_f32_32x32x16_bf16 v[0:15], v[216:219], v[136:139], v[0:15]
    ds_read_b64_tr_b16 v[216:217], v240 offset:28672
    ds_read_b64_tr_b16 v[218:219], v240 offset:30720
    v_exp_f32 v152, v152
    v_exp_f32 v153, v153
    v_mfma_f32_32x32x16_bf16 v[16:31], v[220:223], v[136:139], v[16:31]
    ds_read_b64_tr_b16 v[220:221], v241 offset:28672
    ds_read_b64_tr_b16 v[222:223], v241 offset:30720
    v_add_f32 v248, v248, v152
    v_exp_f32 v154, v154
    v_add_f32 v248, v248, v153
    s_waitcnt lgkmcnt(12)
    v_mfma_f32_32x32x16_bf16 v[32:47], v[224:227], v[136:139], v[32:47]
    ds_read_b64_tr_b16 v[224:225], v242 offset:28672
    ds_read_b64_tr_b16 v[226:227], v242 offset:30720
    v_exp_f32 v155, v155
    v_add_f32 v248, v248, v154
    v_cvt_pk_bf16_f32 v152, v152, v153
    v_mfma_f32_32x32x16_bf16 v[48:63], v[228:231], v[136:139], v[48:63]
    ds_read_b64_tr_b16 v[228:229], v243 offset:28672
    ds_read_b64_tr_b16 v[230:231], v243 offset:30720
    v_exp_f32 v156, v156
    v_add_f32 v248, v248, v155
    s_waitcnt lgkmcnt(12)
    v_mfma_f32_32x32x16_bf16 v[0:15], v[200:203], v[144:147], v[0:15]
    v_exp_f32 v157, v157
    v_add_f32 v248, v248, v156
    v_cvt_pk_bf16_f32 v153, v154, v155
    v_mfma_f32_32x32x16_bf16 v[16:31], v[204:207], v[144:147], v[16:31]
    v_exp_f32 v158, v158
    v_add_f32 v248, v248, v157
    s_waitcnt lgkmcnt(8)
    v_mfma_f32_32x32x16_bf16 v[32:47], v[208:211], v[144:147], v[32:47]
    v_exp_f32 v159, v159
    v_add_f32 v248, v248, v158
    v_mfma_f32_32x32x16_bf16 v[48:63], v[212:215], v[144:147], v[48:63]
    v_cvt_pk_bf16_f32 v154, v156, v157
    v_add_f32 v248, v248, v159
    v_cvt_pk_bf16_f32 v155, v158, v159
    s_waitcnt lgkmcnt(4)
    s_nop 0
    v_mfma_f32_32x32x16_bf16 v[0:15], v[216:219], v[152:155], v[0:15]
    v_max3_f32 v252, v96, v97, v98
    v_max3_f32 v253, v112, v113, v114
    v_max3_f32 v252, v252, v99, v100
    v_max3_f32 v253, v253, v115, v116
    s_waitcnt lgkmcnt(0)
    s_barrier
    ds_read_b128 v[176:179], v232 offset:49152
    ds_read_b128 v[180:183], v233 offset:49152
    ds_read_b128 v[184:187], v234 offset:49152
    v_mfma_f32_32x32x16_bf16 v[16:31], v[220:223], v[152:155], v[16:31]
    ds_read_b128 v[188:191], v235 offset:49152
    ds_read_b128 v[192:195], v236 offset:49152
    ds_read_b128 v[196:199], v237 offset:49152
    v_max3_f32 v252, v252, v101, v102
    v_max3_f32 v253, v253, v117, v118
    v_max3_f32 v252, v252, v103, v104
    v_max3_f32 v253, v253, v119, v120
    v_max3_f32 v252, v252, v105, v106
    v_mfma_f32_32x32x16_bf16 v[32:47], v[224:227], v[152:155], v[32:47]
    v_max3_f32 v253, v253, v121, v122
    v_max3_f32 v252, v252, v107, v108
    v_max3_f32 v253, v253, v123, v124
    v_max3_f32 v252, v252, v109, v110
    v_max3_f32 v253, v253, v125, v126
    v_max3_f32 v252, v252, v111, v127
    v_max_f32 v252, v252, v253
    v_cmp_lt_f32 vcc, 0x41000000, v252
    v_mfma_f32_32x32x16_bf16 v[48:63], v[228:231], v[152:155], v[48:63]
    s_nop 0
    s_cbranch_vccnz RARE_L2
BACK_L2:
    v_exp_f32 v96, v96
    v_exp_f32 v97, v97
    s_waitcnt lgkmcnt(4)
    v_mfma_f32_32x32x16_bf16 v[128:143], v[176:179], v[64:67], v[160:175]
    ds_read_b128 v[176:179], v238 offset:49152
    v_add_f32 v248, v248, v96
    v_exp_f32 v98, v98
    v_add_f32 v248, v248, v97
    v_exp_f32 v99, v99
    v_mfma_f32_32x32x16_bf16 v[128:143], v[180:183], v[68:71], v[128:143]
    ds_read_b128 v[180:183], v239 offset:49152
    v_add_f32 v248, v248, v98
    v_cvt_pk_bf16_f32 v96, v96, v97
    v_exp_f32 v100, v100
    v_add_f32 v248, v248, v99
    s_waitcnt lgkmcnt(4)
    v_mfma_f32_32x32x16_bf16 v[128:143], v[184:187], v[72:75], v[128:143]
    ds_read_b128 v[184:187], v232 offset:57344
    v_exp_f32 v101, v101
    v_add_f32 v248, v248, v100
    v_cvt_pk_bf16_f32 v97, v98, v99
    v_exp_f32 v102, v102
    v_mfma_f32_32x32x16_bf16 v[128:143], v[188:191], v[76:79], v[128:143]
    ds_read_b128 v[188:191], v233 offset:57344
    v_add_f32 v248, v248, v101
    v_exp_f32 v103, v103
    v_add_f32 v248, v248, v102
    s_waitcnt lgkmcnt(4)
    v_mfma_f32_32x32x16_bf16 v[128:143], v[192:195], v[80:83], v[128:143]
    ds_read_b128 v[192:195], v234 offset:57344
    v_cvt_pk_bf16_f32 v98, v100, v101
    v_add_f32 v248, v248, v103
    v_cvt_pk_bf16_f32 v99, v102, v103
    v_exp_f32 v104, v104
    v_exp_f32 v105, v105
    v_mfma_f32_32x32x16_bf16 v[128:143], v[196:199], v[84:87], v[128:143]
    ds_read_b128 v[196:199], v235 offset:57344
    v_add_f32 v248, v248, v104
    v_exp_f32 v106, v106
    v_add_f32 v248, v248, v105
    s_waitcnt lgkmcnt(4)
    v_mfma_f32_32x32x16_bf16 v[128:143], v[176:179], v[88:91], v[128:143]
    ds_read_b128 v[176:179], v236 offset:57344
    v_exp_f32 v107, v107
    v_add_f32 v248, v248, v106
    v_cvt_pk_bf16_f32 v104, v104, v105
    v_exp_f32 v108, v108
    v_mfma_f32_32x32x16_bf16 v[128:143], v[180:183], v[92:95], v[128:143]
    ds_read_b128 v[180:183], v237 offset:57344
    v_add_f32 v248, v248, v107
    v_exp_f32 v109, v109
    v_add_f32 v248, v248, v108
    s_waitcnt lgkmcnt(4)
    v_mfma_f32_32x32x16_bf16 v[144:159], v[184:187], v[64:67], v[160:175]
    ds_read_b128 v[184:187], v238 offset:57344
    v_cvt_pk_bf16_f32 v105, v106, v107
    v_exp_f32 v110, v110
    v_add_f32 v248, v248, v109
    v_exp_f32 v111, v111
    v_mfma_f32_32x32x16_bf16 v[144:159], v[188:191], v[68:71], v[144:159]
    ds_read_b128 v[188:191], v239 offset:57344
    v_add_f32 v248, v248, v110
    v_cvt_pk_bf16_f32 v106, v108, v109
    v_add_f32 v248, v248, v111
    v_cvt_pk_bf16_f32 v107, v110, v111
    v_exp_f32 v112, v112
    s_waitcnt lgkmcnt(4)
    v_mfma_f32_32x32x16_bf16 v[144:159], v[192:195], v[72:75], v[144:159]
    v_exp_f32 v113, v113
    v_add_f32 v248, v248, v112
    v_exp_f32 v114, v114
    v_mfma_f32_32x32x16_bf16 v[144:159], v[196:199], v[76:79], v[144:159]
    v_add_f32 v248, v248, v113
    v_exp_f32 v115, v115
    v_add_f32 v248, v248, v114
    s_waitcnt lgkmcnt(2)
    v_mfma_f32_32x32x16_bf16 v[144:159], v[176:179], v[80:83], v[144:159]
    v_cvt_pk_bf16_f32 v112, v112, v113
    ds_read_b64_tr_b16 v[200:201], v240 offset:32768
    ds_read_b64_tr_b16 v[202:203], v240 offset:34816
    ds_read_b64_tr_b16 v[204:205], v241 offset:32768
    ds_read_b64_tr_b16 v[206:207], v241 offset:34816
    ds_read_b64_tr_b16 v[208:209], v242 offset:32768
    v_mfma_f32_32x32x16_bf16 v[144:159], v[180:183], v[84:87], v[144:159]
    ds_read_b64_tr_b16 v[210:211], v242 offset:34816
    ds_read_b64_tr_b16 v[212:213], v243 offset:32768
    ds_read_b64_tr_b16 v[214:215], v243 offset:34816
    ds_read_b64_tr_b16 v[216:217], v240 offset:36864
    ds_read_b64_tr_b16 v[218:219], v240 offset:38912
    s_waitcnt lgkmcnt(10)
    v_mfma_f32_32x32x16_bf16 v[144:159], v[184:187], v[88:91], v[144:159]
    ds_read_b64_tr_b16 v[220:221], v241 offset:36864
    ds_read_b64_tr_b16 v[222:223], v241 offset:38912
    ds_read_b64_tr_b16 v[224:225], v242 offset:36864
    ds_read_b64_tr_b16 v[226:227], v242 offset:38912
    ds_read_b64_tr_b16 v[228:229], v243 offset:36864
    v_mfma_f32_32x32x16_bf16 v[144:159], v[188:191], v[92:95], v[144:159]
    ds_read_b64_tr_b16 v[230:231], v243 offset:38912
    s_waitcnt lgkmcnt(12)
    v_mfma_f32_32x32x16_bf16 v[0:15], v[200:203], v[96:99], v[0:15]
    ds_read_b64_tr_b16 v[200:201], v240 offset:40960
    ds_read_b64_tr_b16 v[202:203], v240 offset:43008
    v_exp_f32 v116, v116
    v_add_f32 v248, v248, v115
    v_exp_f32 v117, v117
    v_mfma_f32_32x32x16_bf16 v[16:31], v[204:207], v[96:99], v[16:31]
    ds_read_b64_tr_b16 v[204:205], v241 offset:40960
    ds_read_b64_tr_b16 v[206:207], v241 offset:43008
    v_add_f32 v248, v248, v116
    v_cvt_pk_bf16_f32 v113, v114, v115
    v_exp_f32 v118, v118
    s_waitcnt lgkmcnt(12)
    v_mfma_f32_32x32x16_bf16 v[32:47], v[208:211], v[96:99], v[32:47]
    ds_read_b64_tr_b16 v[208:209], v242 offset:40960
    ds_read_b64_tr_b16 v[210:211], v242 offset:43008
    v_add_f32 v248, v248, v117
    v_exp_f32 v119, v119
    v_mfma_f32_32x32x16_bf16 v[48:63], v[212:215], v[96:99], v[48:63]
    ds_read_b64_tr_b16 v[212:213], v243 offset:40960
    ds_read_b64_tr_b16 v[214:215], v243 offset:43008
    v_add_f32 v248, v248, v118
    v_cvt_pk_bf16_f32 v114, v116, v117
    v_add_f32 v248, v248, v119
    v_cvt_pk_bf16_f32 v115, v118, v119
    s_waitcnt lgkmcnt(12)
    v_mfma_f32_32x32x16_bf16 v[0:15], v[216:219], v[104:107], v[0:15]
    ds_read_b64_tr_b16 v[216:217], v240 offset:45056
    ds_read_b64_tr_b16 v[218:219], v240 offset:47104
    v_exp_f32 v120, v120
    v_exp_f32 v121, v121
    v_mfma_f32_32x32x16_bf16 v[16:31], v[220:223], v[104:107], v[16:31]
    ds_read_b64_tr_b16 v[220:221], v241 offset:45056
    ds_read_b64_tr_b16 v[222:223], v241 offset:47104
    v_add_f32 v248, v248, v120
    v_exp_f32 v122, v122
    v_add_f32 v248, v248, v121
    s_waitcnt lgkmcnt(12)
    v_mfma_f32_32x32x16_bf16 v[32:47], v[224:227], v[104:107], v[32:47]
    ds_read_b64_tr_b16 v[224:225], v242 offset:45056
    ds_read_b64_tr_b16 v[226:227], v242 offset:47104
    v_exp_f32 v123, v123
    v_add_f32 v248, v248, v122
    v_cvt_pk_bf16_f32 v120, v120, v121
    v_mfma_f32_32x32x16_bf16 v[48:63], v[228:231], v[104:107], v[48:63]
    ds_read_b64_tr_b16 v[228:229], v243 offset:45056
    ds_read_b64_tr_b16 v[230:231], v243 offset:47104
    v_exp_f32 v124, v124
    v_add_f32 v248, v248, v123
    s_waitcnt lgkmcnt(12)
    v_mfma_f32_32x32x16_bf16 v[0:15], v[200:203], v[112:115], v[0:15]
    v_exp_f32 v125, v125
    v_add_f32 v248, v248, v124
    v_cvt_pk_bf16_f32 v121, v122, v123
    v_mfma_f32_32x32x16_bf16 v[16:31], v[204:207], v[112:115], v[16:31]
    v_exp_f32 v126, v126
    v_add_f32 v248, v248, v125
    s_waitcnt lgkmcnt(8)
    v_mfma_f32_32x32x16_bf16 v[32:47], v[208:211], v[112:115], v[32:47]
    v_exp_f32 v127, v127
    v_add_f32 v248, v248, v126
    v_mfma_f32_32x32x16_bf16 v[48:63], v[212:215], v[112:115], v[48:63]
    v_cvt_pk_bf16_f32 v122, v124, v125
    v_add_f32 v248, v248, v127
    v_cvt_pk_bf16_f32 v123, v126, v127
    s_waitcnt lgkmcnt(4)
    s_nop 0
    v_mfma_f32_32x32x16_bf16 v[0:15], v[216:219], v[120:123], v[0:15]
    v_max3_f32 v252, v128, v129, v130
    v_max3_f32 v253, v144, v145, v146
    v_max3_f32 v252, v252, v131, v132
    v_max3_f32 v253, v253, v147, v148
    s_waitcnt lgkmcnt(0)
    s_barrier
    ds_read_b128 v[176:179], v232 offset:0
    ds_read_b128 v[180:183], v233 offset:0
    ds_read_b128 v[184:187], v234 offset:0
    v_mfma_f32_32x32x16_bf16 v[16:31], v[220:223], v[120:123], v[16:31]
    ds_read_b128 v[188:191], v235 offset:0
    ds_read_b128 v[192:195], v236 offset:0
    ds_read_b128 v[196:199], v237 offset:0
    v_max3_f32 v252, v252, v133, v134
    v_max3_f32 v253, v253, v149, v150
    v_max3_f32 v252, v252, v135, v136
    v_max3_f32 v253, v253, v151, v152
    v_max3_f32 v252, v252, v137, v138
    v_mfma_f32_32x32x16_bf16 v[32:47], v[224:227], v[120:123], v[32:47]
    v_max3_f32 v253, v253, v153, v154
    v_max3_f32 v252, v252, v139, v140
    v_max3_f32 v253, v253, v155, v156
    v_max3_f32 v252, v252, v141, v142
    v_max3_f32 v253, v253, v157, v158
    v_max3_f32 v252, v252, v143, v159
    v_max_f32 v252, v252, v253
    v_cmp_lt_f32 vcc, 0x41000000, v252
    v_mfma_f32_32x32x16_bf16 v[48:63], v[228:231], v[120:123], v[48:63]
    s_nop 0
    s_cbranch_vccnz RARE_L3
BACK_L3:
    v_exp_f32 v128, v128
    v_exp_f32 v129, v129
    s_waitcnt lgkmcnt(4)
    v_mfma_f32_32x32x16_bf16 v[96:111], v[176:179], v[64:67], v[160:175]
    ds_read_b128 v[176:179], v238 offset:0
    v_add_f32 v248, v248, v128
    v_exp_f32 v130, v130
    v_add_f32 v248, v248, v129
    v_exp_f32 v131, v131
    v_mfma_f32_32x32x16_bf16 v[96:111], v[180:183], v[68:71], v[96:111]
    ds_read_b128 v[180:183], v239 offset:0
    v_add_f32 v248, v248, v130
    v_cvt_pk_bf16_f32 v128, v128, v129
    v_exp_f32 v132, v132
    v_add_f32 v248, v248, v131
    s_waitcnt lgkmcnt(4)
    v_mfma_f32_32x32x16_bf16 v[96:111], v[184:187], v[72:75], v[96:111]
    ds_read_b128 v[184:187], v232 offset:8192
    v_exp_f32 v133, v133
    v_add_f32 v248, v248, v132
    v_cvt_pk_bf16_f32 v129, v130, v131
    v_exp_f32 v134, v134
    v_mfma_f32_32x32x16_bf16 v[96:111], v[188:191], v[76:79], v[96:111]
    ds_read_b128 v[188:191], v233 offset:8192
    v_add_f32 v248, v248, v133
    v_exp_f32 v135, v135
    v_add_f32 v248, v248, v134
    s_waitcnt lgkmcnt(4)
    v_mfma_f32_32x32x16_bf16 v[96:111], v[192:195], v[80:83], v[96:111]
    ds_read_b128 v[192:195], v234 offset:8192
    v_cvt_pk_bf16_f32 v130, v132, v133
    v_add_f32 v248, v248, v135
    v_cvt_pk_bf16_f32 v131, v134, v135
    v_exp_f32 v136, v136
    v_exp_f32 v137, v137
    v_mfma_f32_32x32x16_bf16 v[96:111], v[196:199], v[84:87], v[96:111]
    ds_read_b128 v[196:199], v235 offset:8192
    v_add_f32 v248, v248, v136
    v_exp_f32 v138, v138
    v_add_f32 v248, v248, v137
    s_waitcnt lgkmcnt(4)
    v_mfma_f32_32x32x16_bf16 v[96:111], v[176:179], v[88:91], v[96:111]
    ds_read_b128 v[176:179], v236 offset:8192
    v_exp_f32 v139, v139
    v_add_f32 v248, v248, v138
    v_cvt_pk_bf16_f32 v136, v136, v137
    v_exp_f32 v140, v140
    v_mfma_f32_32x32x16_bf16 v[96:111], v[180:183], v[92:95], v[96:111]
    ds_read_b128 v[180:183], v237 offset:8192
    v_add_f32 v248, v248, v139
    v_exp_f32 v141, v141
    v_add_f32 v248, v248, v140
    s_waitcnt lgkmcnt(4)
    v_mfma_f32_32x32x16_bf16 v[112:127], v[184:187], v[64:67], v[160:175]
    ds_read_b128 v[184:187], v238 offset:8192
    v_cvt_pk_bf16_f32 v137, v138, v139
    v_exp_f32 v142, v142
    v_add_f32 v248, v248, v141
    v_exp_f32 v143, v143
    v_mfma_f32_32x32x16_bf16 v[112:127], v[188:191], v[68:71], v[112:127]
    ds_read_b128 v[188:191], v239 offset:8192
    v_add_f32 v248, v248, v142
    v_cvt_pk_bf16_f32 v138, v140, v141
    v_add_f32 v248, v248, v143
    v_cvt_pk_bf16_f32 v139, v142, v143
    v_exp_f32 v144, v144
    s_waitcnt lgkmcnt(4)
    v_mfma_f32_32x32x16_bf16 v[112:127], v[192:195], v[72:75], v[112:127]
    v_exp_f32 v145, v145
    v_add_f32 v248, v248, v144
    v_exp_f32 v146, v146
    v_mfma_f32_32x32x16_bf16 v[112:127], v[196:199], v[76:79], v[112:127]
    v_add_f32 v248, v248, v145
    v_exp_f32 v147, v147
    v_add_f32 v248, v248, v146
    s_waitcnt lgkmcnt(2)
    v_mfma_f32_32x32x16_bf16 v[112:127], v[176:179], v[80:83], v[112:127]
    v_cvt_pk_bf16_f32 v144, v144, v145
    ds_read_b64_tr_b16 v[200:201], v240 offset:49152
    ds_read_b64_tr_b16 v[202:203], v240 offset:51200
    ds_read_b64_tr_b16 v[204:205], v241 offset:49152
    ds_read_b64_tr_b16 v[206:207], v241 offset:51200
    ds_read_b64_tr_b16 v[208:209], v242 offset:49152
    v_mfma_f32_32x32x16_bf16 v[112:127], v[180:183], v[84:87], v[112:127]
    ds_read_b64_tr_b16 v[210:211], v242 offset:51200
    ds_read_b64_tr_b16 v[212:213], v243 offset:49152
    ds_read_b64_tr_b16 v[214:215], v243 offset:51200
    ds_read_b64_tr_b16 v[216:217], v240 offset:53248
    ds_read_b64_tr_b16 v[218:219], v240 offset:55296
    s_waitcnt lgkmcnt(10)
    v_mfma_f32_32x32x16_bf16 v[112:127], v[184:187], v[88:91], v[112:127]
    ds_read_b64_tr_b16 v[220:221], v241 offset:53248
    ds_read_b64_tr_b16 v[222:223], v241 offset:55296
    ds_read_b64_tr_b16 v[224:225], v242 offset:53248
    ds_read_b64_tr_b16 v[226:227], v242 offset:55296
    ds_read_b64_tr_b16 v[228:229], v243 offset:53248
    v_mfma_f32_32x32x16_bf16 v[112:127], v[188:191], v[92:95], v[112:127]
    ds_read_b64_tr_b16 v[230:231], v243 offset:55296
    s_waitcnt lgkmcnt(12)
    v_mfma_f32_32x32x16_bf16 v[0:15], v[200:203], v[128:131], v[0:15]
    ds_read_b64_tr_b16 v[200:201], v240 offset:57344
    ds_read_b64_tr_b16 v[202:203], v240 offset:59392
    v_exp_f32 v148, v148
    v_add_f32 v248, v248, v147
    v_exp_f32 v149, v149
    v_mfma_f32_32x32x16_bf16 v[16:31], v[204:207], v[128:131], v[16:31]
    ds_read_b64_tr_b16 v[204:205], v241 offset:57344
    ds_read_b64_tr_b16 v[206:207], v241 offset:59392
    v_add_f32 v248, v248, v148
    v_cvt_pk_bf16_f32 v145, v146, v147
    v_exp_f32 v150, v150
    s_waitcnt lgkmcnt(12)
    v_mfma_f32_32x32x16_bf16 v[32:47], v[208:211], v[128:131], v[32:47]
    ds_read_b64_tr_b16 v[208:209], v242 offset:57344
    ds_read_b64_tr_b16 v[210:211], v242 offset:59392
    v_add_f32 v248, v248, v149
    v_exp_f32 v151, v151
    v_mfma_f32_32x32x16_bf16 v[48:63], v[212:215], v[128:131], v[48:63]
    ds_read_b64_tr_b16 v[212:213], v243 offset:57344
    ds_read_b64_tr_b16 v[214:215], v243 offset:59392
    v_add_f32 v248, v248, v150
    v_cvt_pk_bf16_f32 v146, v148, v149
    v_add_f32 v248, v248, v151
    v_cvt_pk_bf16_f32 v147, v150, v151
    s_waitcnt lgkmcnt(12)
    v_mfma_f32_32x32x16_bf16 v[0:15], v[216:219], v[136:139], v[0:15]
    ds_read_b64_tr_b16 v[216:217], v240 offset:61440
    ds_read_b64_tr_b16 v[218:219], v240 offset:63488
    v_exp_f32 v152, v152
    v_exp_f32 v153, v153
    v_mfma_f32_32x32x16_bf16 v[16:31], v[220:223], v[136:139], v[16:31]
    ds_read_b64_tr_b16 v[220:221], v241 offset:61440
    ds_read_b64_tr_b16 v[222:223], v241 offset:63488
    v_add_f32 v248, v248, v152
    v_exp_f32 v154, v154
    v_add_f32 v248, v248, v153
    s_waitcnt lgkmcnt(12)
    v_mfma_f32_32x32x16_bf16 v[32:47], v[224:227], v[136:139], v[32:47]
    ds_read_b64_tr_b16 v[224:225], v242 offset:61440
    ds_read_b64_tr_b16 v[226:227], v242 offset:63488
    v_exp_f32 v155, v155
    v_add_f32 v248, v248, v154
    v_cvt_pk_bf16_f32 v152, v152, v153
    v_mfma_f32_32x32x16_bf16 v[48:63], v[228:231], v[136:139], v[48:63]
    ds_read_b64_tr_b16 v[228:229], v243 offset:61440
    ds_read_b64_tr_b16 v[230:231], v243 offset:63488
    v_exp_f32 v156, v156
    v_add_f32 v248, v248, v155
    s_waitcnt lgkmcnt(12)
    v_mfma_f32_32x32x16_bf16 v[0:15], v[200:203], v[144:147], v[0:15]
    v_exp_f32 v157, v157
    v_add_f32 v248, v248, v156
    v_cvt_pk_bf16_f32 v153, v154, v155
    v_mfma_f32_32x32x16_bf16 v[16:31], v[204:207], v[144:147], v[16:31]
    v_exp_f32 v158, v158
    v_add_f32 v248, v248, v157
    s_waitcnt lgkmcnt(8)
    v_mfma_f32_32x32x16_bf16 v[32:47], v[208:211], v[144:147], v[32:47]
    v_exp_f32 v159, v159
    v_add_f32 v248, v248, v158
    v_mfma_f32_32x32x16_bf16 v[48:63], v[212:215], v[144:147], v[48:63]
    v_cvt_pk_bf16_f32 v154, v156, v157
    v_add_f32 v248, v248, v159
    v_cvt_pk_bf16_f32 v155, v158, v159
    s_sub_u32 s51, s51, 1
    s_cmp_lg_u32 s51, 0
    s_cbranch_scc1 K1_LOOP
    s_waitcnt lgkmcnt(4)
    v_mfma_f32_32x32x16_bf16 v[0:15], v[216:219], v[152:155], v[0:15]
    v_mfma_f32_32x32x16_bf16 v[16:31], v[220:223], v[152:155], v[16:31]
    s_waitcnt lgkmcnt(0)
    v_mfma_f32_32x32x16_bf16 v[32:47], v[224:227], v[152:155], v[32:47]
    v_mfma_f32_32x32x16_bf16 v[48:63], v[228:231], v[152:155], v[48:63]
    v_add_f32 v248, v248, v249
    v_mov_b32 v252, v248
    s_nop 1
    v_permlane32_swap_b32 v248, v252
    v_add_f32 v248, v248, v252
    v_rcp_f32 v253, v248
    v_mbcnt_lo_u32_b32 v252, -1, 0
    v_mbcnt_hi_u32_b32 v252, -1, v252
    v_lshlrev_b32 v248, 4, v252
    s_lshl_b32 s43, s17, 15
    s_lshl_b32 s41, s14, 12
    s_add_u32 s43, s43, s41
    s_add_u32 s42, s43, 16384
    v_and_b32 v244, 31, v252
    s_lshl_b32 s40, s14, 5
    v_add_u32 v244, s40, v244
    v_bfe_u32 v245, v244, 1, 3
    v_lshrrev_b32 v246, 5, v252
    v_add_u32 v247, 0, v246
    v_xor_b32 v247, v247, v245
    v_lshlrev_b32 v247, 4, v247
    v_lshl_add_u32 v232, v244, 7, v247
    v_add_u32 v247, 2, v246
    v_xor_b32 v247, v247, v245
    v_lshlrev_b32 v247, 4, v247
    v_lshl_add_u32 v233, v244, 7, v247
    v_add_u32 v247, 4, v246
    v_xor_b32 v247, v247, v245
    v_lshlrev_b32 v247, 4, v247
    v_lshl_add_u32 v234, v244, 7, v247
    v_add_u32 v247, 6, v246
    v_xor_b32 v247, v247, v245
    v_lshlrev_b32 v247, 4, v247
    v_lshl_add_u32 v235, v244, 7, v247
    v_add_u32 v236, s41, v248
    v_mul_f32 v0, v0, v253
    v_mul_f32 v1, v1, v253
    v_mul_f32 v2, v2, v253
    v_mul_f32 v3, v3, v253
    v_mul_f32 v4, v4, v253
    v_mul_f32 v5, v5, v253
    v_mul_f32 v6, v6, v253
    v_mul_f32 v7, v7, v253
    v_cvt_pk_bf16_f32 v64, v0, v1
    v_cvt_pk_bf16_f32 v65, v2, v3
    v_cvt_pk_bf16_f32 v66, v4, v5
    v_cvt_pk_bf16_f32 v67, v6, v7
    s_nop 0
    v_permlane32_swap_b32 v64, v66
    v_permlane32_swap_b32 v65, v67
    ds_write_b128 v232, v[64:67] offset:0
    v_mul_f32 v8, v8, v253
    v_mul_f32 v9, v9, v253
    v_mul_f32 v10, v10, v253
    v_mul_f32 v11, v11, v253
    v_mul_f32 v12, v12, v253
    v_mul_f32 v13, v13, v253
    v_mul_f32 v14, v14, v253
    v_mul_f32 v15, v15, v253
    v_cvt_pk_bf16_f32 v68, v8, v9
    v_cvt_pk_bf16_f32 v69, v10, v11
    v_cvt_pk_bf16_f32 v70, v12, v13
    v_cvt_pk_bf16_f32 v71, v14, v15
    s_nop 0
    v_permlane32_swap_b32 v68, v70
    v_permlane32_swap_b32 v69, v71
    ds_write_b128 v233, v[68:71] offset:0
    v_mul_f32 v16, v16, v253
    v_mul_f32 v17, v17, v253
    v_mul_f32 v18, v18, v253
    v_mul_f32 v19, v19, v253
    v_mul_f32 v20, v20, v253
    v_mul_f32 v21, v21, v253
    v_mul_f32 v22, v22, v253
    v_mul_f32 v23, v23, v253
    v_cvt_pk_bf16_f32 v72, v16, v17
    v_cvt_pk_bf16_f32 v73, v18, v19
    v_cvt_pk_bf16_f32 v74, v20, v21
    v_cvt_pk_bf16_f32 v75, v22, v23
    s_nop 0
    v_permlane32_swap_b32 v72, v74
    v_permlane32_swap_b32 v73, v75
    ds_write_b128 v234, v[72:75] offset:0
    v_mul_f32 v24, v24, v253
    v_mul_f32 v25, v25, v253
    v_mul_f32 v26, v26, v253
    v_mul_f32 v27, v27, v253
    v_mul_f32 v28, v28, v253
    v_mul_f32 v29, v29, v253
    v_mul_f32 v30, v30, v253
    v_mul_f32 v31, v31, v253
    v_cvt_pk_bf16_f32 v76, v24, v25
    v_cvt_pk_bf16_f32 v77, v26, v27
    v_cvt_pk_bf16_f32 v78, v28, v29
    v_cvt_pk_bf16_f32 v79, v30, v31
    s_nop 0
    v_permlane32_swap_b32 v76, v78
    v_permlane32_swap_b32 v77, v79
    ds_write_b128 v235, v[76:79] offset:0
    ds_read_b128 v[96:99], v236 offset:0
    ds_read_b128 v[100:103], v236 offset:1024
    ds_read_b128 v[104:107], v236 offset:2048
    ds_read_b128 v[108:111], v236 offset:3072
    v_mul_f32 v32, v32, v253
    v_mul_f32 v33, v33, v253
    v_mul_f32 v34, v34, v253
    v_mul_f32 v35, v35, v253
    v_mul_f32 v36, v36, v253
    v_mul_f32 v37, v37, v253
    v_mul_f32 v38, v38, v253
    v_mul_f32 v39, v39, v253
    v_cvt_pk_bf16_f32 v80, v32, v33
    v_cvt_pk_bf16_f32 v81, v34, v35
    v_cvt_pk_bf16_f32 v82, v36, v37
    v_cvt_pk_bf16_f32 v83, v38, v39
    s_nop 0
    v_permlane32_swap_b32 v80, v82
    v_permlane32_swap_b32 v81, v83
    ds_write_b128 v232, v[80:83] offset:16384
    v_mul_f32 v40, v40, v253
    v_mul_f32 v41, v41, v253
    v_mul_f32 v42, v42, v253
    v_mul_f32 v43, v43, v253
    v_mul_f32 v44, v44, v253
    v_mul_f32 v45, v45, v253
    v_mul_f32 v46, v46, v253
    v_mul_f32 v47, v47, v253
    v_cvt_pk_bf16_f32 v84, v40, v41
    v_cvt_pk_bf16_f32 v85, v42, v43
    v_cvt_pk_bf16_f32 v86, v44, v45
    v_cvt_pk_bf16_f32 v87, v46, v47
    s_nop 0
    v_permlane32_swap_b32 v84, v86
    v_permlane32_swap_b32 v85, v87
    ds_write_b128 v233, v[84:87] offset:16384
    v_mul_f32 v48, v48, v253
    v_mul_f32 v49, v49, v253
    v_mul_f32 v50, v50, v253
    v_mul_f32 v51, v51, v253
    v_mul_f32 v52, v52, v253
    v_mul_f32 v53, v53, v253
    v_mul_f32 v54, v54, v253
    v_mul_f32 v55, v55, v253
    v_cvt_pk_bf16_f32 v88, v48, v49
    v_cvt_pk_bf16_f32 v89, v50, v51
    v_cvt_pk_bf16_f32 v90, v52, v53
    v_cvt_pk_bf16_f32 v91, v54, v55
    s_nop 0
    v_permlane32_swap_b32 v88, v90
    v_permlane32_swap_b32 v89, v91
    ds_write_b128 v234, v[88:91] offset:16384
    v_mul_f32 v56, v56, v253
    v_mul_f32 v57, v57, v253
    v_mul_f32 v58, v58, v253
    v_mul_f32 v59, v59, v253
    v_mul_f32 v60, v60, v253
    v_mul_f32 v61, v61, v253
    v_mul_f32 v62, v62, v253
    v_mul_f32 v63, v63, v253
    v_cvt_pk_bf16_f32 v92, v56, v57
    v_cvt_pk_bf16_f32 v93, v58, v59
    v_cvt_pk_bf16_f32 v94, v60, v61
    v_cvt_pk_bf16_f32 v95, v62, v63
    s_nop 0
    v_permlane32_swap_b32 v92, v94
    v_permlane32_swap_b32 v93, v95
    ds_write_b128 v235, v[92:95] offset:16384
    ds_read_b128 v[112:115], v236 offset:16384
    ds_read_b128 v[116:119], v236 offset:17408
    ds_read_b128 v[120:123], v236 offset:18432
    ds_read_b128 v[124:127], v236 offset:19456
    s_waitcnt lgkmcnt(11)
    buffer_store_dwordx4 v[96:99], v248, s[36:39], s43 offen offset:0 sc1
    s_waitcnt lgkmcnt(10)
    buffer_store_dwordx4 v[100:103], v248, s[36:39], s43 offen offset:1024 sc1
    s_waitcnt lgkmcnt(9)
    buffer_store_dwordx4 v[104:107], v248, s[36:39], s43 offen offset:2048 sc1
    s_waitcnt lgkmcnt(8)
    buffer_store_dwordx4 v[108:111], v248, s[36:39], s43 offen offset:3072 sc1
    s_waitcnt lgkmcnt(3)
    buffer_store_dwordx4 v[112:115], v248, s[36:39], s42 offen offset:0 sc1
    s_waitcnt lgkmcnt(2)
    buffer_store_dwordx4 v[116:119], v248, s[36:39], s42 offen offset:1024 sc1
    s_waitcnt lgkmcnt(1)
    buffer_store_dwordx4 v[120:123], v248, s[36:39], s42 offen offset:2048 sc1
    s_waitcnt lgkmcnt(0)
    buffer_store_dwordx4 v[124:127], v248, s[36:39], s42 offen offset:3072 sc1
    v_and_b32 v236, 31, v252
    v_lshrrev_b32 v237, 5, v252
    v_bfe_u32 v238, v252, 2, 2
    v_bfe_u32 v245, v252, 4, 1
    v_and_b32 v246, 3, v252
    v_lshlrev_b32 v246, 3, v246
    v_lshl_add_u32 v239, v245, 5, v246
    v_lshrrev_b32 v244, 4, v252
    v_lshl_add_u32 v245, v244, 3, v238
    v_and_b32 v246, 3, v252
    v_lshlrev_b32 v246, 3, v246
    v_lshl_add_u32 v245, v245, 8, v246
    v_add_u32 v245, 65536, v245
    v_and_b32 v246, 1, v244
    v_lshl_add_u32 v246, v238, 1, v246
    v_xor_b32 v247, 0, v246
    v_lshl_add_u32 v226, v247, 5, v245
    v_xor_b32 v247, 1, v246
    v_lshl_add_u32 v227, v247, 5, v245
    v_xor_b32 v247, 2, v246
    v_lshl_add_u32 v228, v247, 5, v245
    v_xor_b32 v247, 3, v246
    v_lshl_add_u32 v229, v247, 5, v245
    v_xor_b32 v247, 4, v246
    v_lshl_add_u32 v230, v247, 5, v245
    v_xor_b32 v247, 5, v246
    v_lshl_add_u32 v231, v247, 5, v245
    v_xor_b32 v247, 6, v246
    v_lshl_add_u32 v232, v247, 5, v245
    v_xor_b32 v247, 7, v246
    v_lshl_add_u32 v233, v247, 5, v245
    v_and_b32 v245, 15, v252
    s_lshl_b32 s40, s14, 5
    v_add_u32 v245, s40, v245
    v_bfe_u32 v246, v245, 1, 3
    v_add_u32 v247, 0, v244
    v_xor_b32 v247, v247, v246
    v_lshlrev_b32 v247, 4, v247
    v_lshl_add_u32 v224, v245, 7, v247
    v_add_u32 v247, 4, v244
    v_xor_b32 v247, v247, v246
    v_lshlrev_b32 v247, 4, v247
    v_lshl_add_u32 v225, v245, 7, v247
    s_lshl_b32 s56, s15, 2
    s_add_u32 s56, s56, s18
    s_lshl_b32 s56, s56, 7
    s_lshl_b32 s42, s19, 3
    s_add_u32 s56, s56, s42
    s_add_u32 s56, s56, 0x3000000
    s_waitcnt lgkmcnt(0)
    s_mov_b32 s90, 1
    s_mov_b32 s88, 1
    s_branch GEMM
TAIL_CONT:
    s_lshl_b32 s40, s15, 5
    s_add_u32 s40, s40, s19
    s_lshl_b32 s40, s40, 16
    s_add_u32 s40, s40, 0x1000000
    s_lshl_b32 s41, s14, 12
    s_add_u32 s40, s40, s41
    s_lshl_b32 s41, s18, 14
    s_add_u32 s41, s41, s40
    s_cmp_eq_u32 s18, 0
    s_cbranch_scc1 SKIPST_0
    s_add_u32 s42, s41, 0
    buffer_store_dwordx4 v[0:3], v248, s[36:39], s42 offen offset:0 sc1
    buffer_store_dwordx4 v[4:7], v248, s[36:39], s42 offen offset:1024 sc1
    buffer_store_dwordx4 v[8:11], v248, s[36:39], s42 offen offset:2048 sc1
    buffer_store_dwordx4 v[12:15], v248, s[36:39], s42 offen offset:3072 sc1
SKIPST_0:
    s_cmp_eq_u32 s18, 1
    s_cbranch_scc1 SKIPST_1
    s_add_u32 s42, s41, 524288
    buffer_store_dwordx4 v[16:19], v248, s[36:39], s42 offen offset:0 sc1
    buffer_store_dwordx4 v[20:23], v248, s[36:39], s42 offen offset:1024 sc1
    buffer_store_dwordx4 v[24:27], v248, s[36:39], s42 offen offset:2048 sc1
    buffer_store_dwordx4 v[28:31], v248, s[36:39], s42 offen offset:3072 sc1
SKIPST_1:
    s_cmp_eq_u32 s18, 2
    s_cbranch_scc1 SKIPST_2
    s_add_u32 s42, s41, 1048576
    buffer_store_dwordx4 v[32:35], v248, s[36:39], s42 offen offset:0 sc1
    buffer_store_dwordx4 v[36:39], v248, s[36:39], s42 offen offset:1024 sc1
    buffer_store_dwordx4 v[40:43], v248, s[36:39], s42 offen offset:2048 sc1
    buffer_store_dwordx4 v[44:47], v248, s[36:39], s42 offen offset:3072 sc1
SKIPST_2:
    s_cmp_eq_u32 s18, 3
    s_cbranch_scc1 SKIPST_3
    s_add_u32 s42, s41, 1572864
    buffer_store_dwordx4 v[48:51], v248, s[36:39], s42 offen offset:0 sc1
    buffer_store_dwordx4 v[52:55], v248, s[36:39], s42 offen offset:1024 sc1
    buffer_store_dwordx4 v[56:59], v248, s[36:39], s42 offen offset:2048 sc1
    buffer_store_dwordx4 v[60:63], v248, s[36:39], s42 offen offset:3072 sc1
SKIPST_3:
    s_cmp_lg_u32 s18, 0
    s_cbranch_scc1 SKIPMV_0
    v_mov_b32 v64, v0
    v_mov_b32 v65, v1
    v_mov_b32 v66, v2
    v_mov_b32 v67, v3
    v_mov_b32 v68, v4
    v_mov_b32 v69, v5
    v_mov_b32 v70, v6
    v_mov_b32 v71, v7
    v_mov_b32 v72, v8
    v_mov_b32 v73, v9
    v_mov_b32 v74, v10
    v_mov_b32 v75, v11
    v_mov_b32 v76, v12
    v_mov_b32 v77, v13
    v_mov_b32 v78, v14
    v_mov_b32 v79, v15
SKIPMV_0:
    s_cmp_lg_u32 s18, 1
    s_cbranch_scc1 SKIPMV_1
    v_mov_b32 v64, v16
    v_mov_b32 v65, v17
    v_mov_b32 v66, v18
    v_mov_b32 v67, v19
    v_mov_b32 v68, v20
    v_mov_b32 v69, v21
    v_mov_b32 v70, v22
    v_mov_b32 v71, v23
    v_mov_b32 v72, v24
    v_mov_b32 v73, v25
    v_mov_b32 v74, v26
    v_mov_b32 v75, v27
    v_mov_b32 v76, v28
    v_mov_b32 v77, v29
    v_mov_b32 v78, v30
    v_mov_b32 v79, v31
SKIPMV_1:
    s_cmp_lg_u32 s18, 2
    s_cbranch_scc1 SKIPMV_2
    v_mov_b32 v64, v32
    v_mov_b32 v65, v33
    v_mov_b32 v66, v34
    v_mov_b32 v67, v35
    v_mov_b32 v68, v36
    v_mov_b32 v69, v37
    v_mov_b32 v70, v38
    v_mov_b32 v71, v39
    v_mov_b32 v72, v40
    v_mov_b32 v73, v41
    v_mov_b32 v74, v42
    v_mov_b32 v75, v43
    v_mov_b32 v76, v44
    v_mov_b32 v77, v45
    v_mov_b32 v78, v46
    v_mov_b32 v79, v47
SKIPMV_2:
    s_cmp_lg_u32 s18, 3
    s_cbranch_scc1 SKIPMV_3
    v_mov_b32 v64, v48
    v_mov_b32 v65, v49
    v_mov_b32 v66, v50
    v_mov_b32 v67, v51
    v_mov_b32 v68, v52
    v_mov_b32 v69, v53
    v_mov_b32 v70, v54
    v_mov_b32 v71, v55
    v_mov_b32 v72, v56
    v_mov_b32 v73, v57
    v_mov_b32 v74, v58
    v_mov_b32 v75, v59
    v_mov_b32 v76, v60
    v_mov_b32 v77, v61
    v_mov_b32 v78, v62
    v_mov_b32 v79, v63
SKIPMV_3:
    s_waitcnt vmcnt(0)
    s_barrier
    v_mbcnt_lo_u32_b32 v252, -1, 0
    v_mbcnt_hi_u32_b32 v252, -1, v252
    s_mov_b32 s84, s70
    s_mov_b32 s85, s71
    s_mov_b32 s86, 0x200000
    s_mov_b32 s87, 0x20000
    v_and_b32 v244, 31, v252
    v_lshrrev_b32 v246, 5, v252
    v_lshlrev_b32 v244, 11, v244
    v_lshl_add_u32 v244, v246, 4, v244
    s_lshl_b32 s41, s18, 19
    s_add_u32 s41, s41, s40
    s_barrier
    s_add_u32 s42, s18, 1
    s_and_b32 s42, s42, 3
    s_lshl_b32 s42, s42, 14
    s_add_u32 s42, s42, s41
    buffer_load_dwordx4 v[96:99], v248, s[36:39], s42 offen offset:0 sc1
    buffer_load_dwordx4 v[100:103], v248, s[36:39], s42 offen offset:1024 sc1
    buffer_load_dwordx4 v[104:107], v248, s[36:39], s42 offen offset:2048 sc1
    buffer_load_dwordx4 v[108:111], v248, s[36:39], s42 offen offset:3072 sc1
    s_add_u32 s42, s18, 2
    s_and_b32 s42, s42, 3
    s_lshl_b32 s42, s42, 14
    s_add_u32 s42, s42, s41
    buffer_load_dwordx4 v[112:115], v248, s[36:39], s42 offen offset:0 sc1
    buffer_load_dwordx4 v[116:119], v248, s[36:39], s42 offen offset:1024 sc1
    buffer_load_dwordx4 v[120:123], v248, s[36:39], s42 offen offset:2048 sc1
    buffer_load_dwordx4 v[124:127], v248, s[36:39], s42 offen offset:3072 sc1
    s_add_u32 s42, s18, 3
    s_and_b32 s42, s42, 3
    s_lshl_b32 s42, s42, 14
    s_add_u32 s42, s42, s41
    buffer_load_dwordx4 v[128:131], v248, s[36:39], s42 offen offset:0 sc1
    buffer_load_dwordx4 v[132:135], v248, s[36:39], s42 offen offset:1024 sc1
    buffer_load_dwordx4 v[136:139], v248, s[36:39], s42 offen offset:2048 sc1
    buffer_load_dwordx4 v[140:143], v248, s[36:39], s42 offen offset:3072 sc1
    s_lshl_b32 s42, s15, 2
    s_add_u32 s42, s42, s14
    s_lshl_b32 s42, s42, 16
    s_lshl_b32 s43, s19, 8
    s_add_u32 s42, s42, s43
    s_lshl_b32 s43, s18, 6
    s_add_u32 s42, s42, s43
    s_waitcnt vmcnt(11)
    v_add_f32 v64, v64, v96
    v_add_f32 v65, v65, v97
    v_add_f32 v66, v66, v98
    v_add_f32 v67, v67, v99
    s_waitcnt vmcnt(10)
    v_add_f32 v68, v68, v100
    v_add_f32 v69, v69, v101
    v_add_f32 v70, v70, v102
    v_add_f32 v71, v71, v103
    s_waitcnt vmcnt(9)
    v_add_f32 v72, v72, v104
    v_add_f32 v73, v73, v105
    v_add_f32 v74, v74, v106
    v_add_f32 v75, v75, v107
    s_waitcnt vmcnt(8)
    v_add_f32 v76, v76, v108
    v_add_f32 v77, v77, v109
    v_add_f32 v78, v78, v110
    v_add_f32 v79, v79, v111
    s_waitcnt vmcnt(7)
    v_add_f32 v64, v64, v112
    v_add_f32 v65, v65, v113
    v_add_f32 v66, v66, v114
    v_add_f32 v67, v67, v115
    s_waitcnt vmcnt(6)
    v_add_f32 v68, v68, v116
    v_add_f32 v69, v69, v117
    v_add_f32 v70, v70, v118
    v_add_f32 v71, v71, v119
    s_waitcnt vmcnt(5)
    v_add_f32 v72, v72, v120
    v_add_f32 v73, v73, v121
    v_add_f32 v74, v74, v122
    v_add_f32 v75, v75, v123
    s_waitcnt vmcnt(4)
    v_add_f32 v76, v76, v124
    v_add_f32 v77, v77, v125
    v_add_f32 v78, v78, v126
    v_add_f32 v79, v79, v127
    s_waitcnt vmcnt(3)
    v_add_f32 v64, v64, v128
    v_add_f32 v65, v65, v129
    v_add_f32 v66, v66, v130
    v_add_f32 v67, v67, v131
    s_waitcnt vmcnt(2)
    v_add_f32 v68, v68, v132
    v_add_f32 v69, v69, v133
    v_add_f32 v70, v70, v134
    v_add_f32 v71, v71, v135
    s_waitcnt vmcnt(1)
    v_add_f32 v72, v72, v136
    v_add_f32 v73, v73, v137
    v_add_f32 v74, v74, v138
    v_add_f32 v75, v75, v139
    s_waitcnt vmcnt(0)
    v_add_f32 v76, v76, v140
    v_add_f32 v77, v77, v141
    v_add_f32 v78, v78, v142
    v_add_f32 v79, v79, v143
    v_cvt_pk_bf16_f32 v80, v64, v65
    v_cvt_pk_bf16_f32 v81, v66, v67
    v_cvt_pk_bf16_f32 v82, v68, v69
    v_cvt_pk_bf16_f32 v83, v70, v71
    v_cvt_pk_bf16_f32 v84, v72, v73
    v_cvt_pk_bf16_f32 v85, v74, v75
    v_cvt_pk_bf16_f32 v86, v76, v77
    v_cvt_pk_bf16_f32 v87, v78, v79
    v_permlane16_swap_b32 v80, v82
    v_permlane16_swap_b32 v81, v83
    buffer_store_dwordx4 v[80:83], v244, s[84:87], s42 offen offset:0
    v_permlane16_swap_b32 v84, v86
    v_permlane16_swap_b32 v85, v87
    buffer_store_dwordx4 v[84:87], v244, s[84:87], s42 offen offset:32
    s_branch K1_END
SIG1:
    s_mov_b32 s90, 0
    s_waitcnt vmcnt(0)
    v_mov_b32 v252, 1
    s_mov_b64 exec, 1
    ds_add_rtn_u32 v253, v250, v252 offset:32
    ds_read_b64 v[244:245], v250 offset:48
    s_waitcnt lgkmcnt(0)
    v_readfirstlane_b32 s53, v253
    s_nop 1
    s_cmp_lg_u32 s53, 3
    s_cbranch_scc1 NOSIG1
    v_mov_b32 v253, 0
    buffer_store_dwordx2 v[244:245], v253, s[36:39], s56 offen sc1
NOSIG1:
    s_mov_b64 exec, -1
    s_branch SIG1_BACK
RARE_L0:
    v_mov_b32 v253, v252
    s_nop 1
    v_permlane32_swap_b32 v252, v253
    v_max3_f32 v252, v252, v253, 0
    v_sub_f32 v253, 0, v252
    v_exp_f32 v253, v253
    v_sub_f32 v160, v160, v252
    v_sub_f32 v161, v161, v252
    v_sub_f32 v162, v162, v252
    v_sub_f32 v163, v163, v252
    v_sub_f32 v164, v164, v252
    v_sub_f32 v165, v165, v252
    v_sub_f32 v166, v166, v252
    v_sub_f32 v167, v167, v252
    v_sub_f32 v168, v168, v252
    v_sub_f32 v169, v169, v252
    v_sub_f32 v170, v170, v252
    v_sub_f32 v171, v171, v252
    v_sub_f32 v172, v172, v252
    v_sub_f32 v173, v173, v252
    v_sub_f32 v174, v174, v252
    v_sub_f32 v175, v175, v252
    v_sub_f32 v96, v96, v252
    v_sub_f32 v97, v97, v252
    v_sub_f32 v98, v98, v252
    v_sub_f32 v99, v99, v252
    v_sub_f32 v100, v100, v252
    v_sub_f32 v101, v101, v252
    v_sub_f32 v102, v102, v252
    v_sub_f32 v103, v103, v252
    v_sub_f32 v104, v104, v252
    v_sub_f32 v105, v105, v252
    v_sub_f32 v106, v106, v252
    v_sub_f32 v107, v107, v252
    v_sub_f32 v108, v108, v252
    v_sub_f32 v109, v109, v252
    v_sub_f32 v110, v110, v252
    v_sub_f32 v111, v111, v252
    v_sub_f32 v112, v112, v252
    v_sub_f32 v113, v113, v252
    v_sub_f32 v114, v114, v252
    v_sub_f32 v115, v115, v252
    v_sub_f32 v116, v116, v252
    v_sub_f32 v117, v117, v252
    v_sub_f32 v118, v118, v252
    v_sub_f32 v119, v119, v252
    v_sub_f32 v120, v120, v252
    v_sub_f32 v121, v121, v252
    v_sub_f32 v122, v122, v252
    v_sub_f32 v123, v123, v252
    v_sub_f32 v124, v124, v252
    v_sub_f32 v125, v125, v252
    v_sub_f32 v126, v126, v252
    v_sub_f32 v127, v127, v252
    v_mul_f32 v248, v248, v253
    v_mul_f32 v249, v249, v253
    v_mul_f32 v0, v0, v253
    v_mul_f32 v1, v1, v253
    v_mul_f32 v2, v2, v253
    v_mul_f32 v3, v3, v253
    v_mul_f32 v4, v4, v253
    v_mul_f32 v5, v5, v253
    v_mul_f32 v6, v6, v253
    v_mul_f32 v7, v7, v253
    v_mul_f32 v8, v8, v253
    v_mul_f32 v9, v9, v253
    v_mul_f32 v10, v10, v253
    v_mul_f32 v11, v11, v253
    v_mul_f32 v12, v12, v253
    v_mul_f32 v13, v13, v253
    v_mul_f32 v14, v14, v253
    v_mul_f32 v15, v15, v253
    v_mul_f32 v16, v16, v253
    v_mul_f32 v17, v17, v253
    v_mul_f32 v18, v18, v253
    v_mul_f32 v19, v19, v253
    v_mul_f32 v20, v20, v253
    v_mul_f32 v21, v21, v253
    v_mul_f32 v22, v22, v253
    v_mul_f32 v23, v23, v253
    v_mul_f32 v24, v24, v253
    v_mul_f32 v25, v25, v253
    v_mul_f32 v26, v26, v253
    v_mul_f32 v27, v27, v253
    v_mul_f32 v28, v28, v253
    v_mul_f32 v29, v29, v253
    v_mul_f32 v30, v30, v253
    v_mul_f32 v31, v31, v253
    v_mul_f32 v32, v32, v253
    v_mul_f32 v33, v33, v253
    v_mul_f32 v34, v34, v253
    v_mul_f32 v35, v35, v253
    v_mul_f32 v36, v36, v253
    v_mul_f32 v37, v37, v253
    v_mul_f32 v38, v38, v253
    v_mul_f32 v39, v39, v253
    v_mul_f32 v40, v40, v253
    v_mul_f32 v41, v41, v253
    v_mul_f32 v42, v42, v253
    v_mul_f32 v43, v43, v253
    v_mul_f32 v44, v44, v253
    v_mul_f32 v45, v45, v253
    v_mul_f32 v46, v46, v253
    v_mul_f32 v47, v47, v253
    v_mul_f32 v48, v48, v253
    v_mul_f32 v49, v49, v253
    v_mul_f32 v50, v50, v253
    v_mul_f32 v51, v51, v253
    v_mul_f32 v52, v52, v253
    v_mul_f32 v53, v53, v253
    v_mul_f32 v54, v54, v253
    v_mul_f32 v55, v55, v253
    v_mul_f32 v56, v56, v253
    v_mul_f32 v57, v57, v253
    v_mul_f32 v58, v58, v253
    v_mul_f32 v59, v59, v253
    v_mul_f32 v60, v60, v253
    v_mul_f32 v61, v61, v253
    v_mul_f32 v62, v62, v253
    v_mul_f32 v63, v63, v253
    s_nop 1
    s_branch BACK_L0
RARE_L1:
    v_mov_b32 v253, v252
    s_nop 1
    v_permlane32_swap_b32 v252, v253
    v_max3_f32 v252, v252, v253, 0
    v_sub_f32 v253, 0, v252
    v_exp_f32 v253, v253
    v_sub_f32 v160, v160, v252
    v_sub_f32 v161, v161, v252
    v_sub_f32 v162, v162, v252
    v_sub_f32 v163, v163, v252
    v_sub_f32 v164, v164, v252
    v_sub_f32 v165, v165, v252
    v_sub_f32 v166, v166, v252
    v_sub_f32 v167, v167, v252
    v_sub_f32 v168, v168, v252
    v_sub_f32 v169, v169, v252
    v_sub_f32 v170, v170, v252
    v_sub_f32 v171, v171, v252
    v_sub_f32 v172, v172, v252
    v_sub_f32 v173, v173, v252
    v_sub_f32 v174, v174, v252
    v_sub_f32 v175, v175, v252
    v_sub_f32 v128, v128, v252
    v_sub_f32 v129, v129, v252
    v_sub_f32 v130, v130, v252
    v_sub_f32 v131, v131, v252
    v_sub_f32 v132, v132, v252
    v_sub_f32 v133, v133, v252
    v_sub_f32 v134, v134, v252
    v_sub_f32 v135, v135, v252
    v_sub_f32 v136, v136, v252
    v_sub_f32 v137, v137, v252
    v_sub_f32 v138, v138, v252
    v_sub_f32 v139, v139, v252
    v_sub_f32 v140, v140, v252
    v_sub_f32 v141, v141, v252
    v_sub_f32 v142, v142, v252
    v_sub_f32 v143, v143, v252
    v_sub_f32 v144, v144, v252
    v_sub_f32 v145, v145, v252
    v_sub_f32 v146, v146, v252
    v_sub_f32 v147, v147, v252
    v_sub_f32 v148, v148, v252
    v_sub_f32 v149, v149, v252
    v_sub_f32 v150, v150, v252
    v_sub_f32 v151, v151, v252
    v_sub_f32 v152, v152, v252
    v_sub_f32 v153, v153, v252
    v_sub_f32 v154, v154, v252
    v_sub_f32 v155, v155, v252
    v_sub_f32 v156, v156, v252
    v_sub_f32 v157, v157, v252
    v_sub_f32 v158, v158, v252
    v_sub_f32 v159, v159, v252
    v_mul_f32 v248, v248, v253
    v_mul_f32 v249, v249, v253
    v_mul_f32 v0, v0, v253
    v_mul_f32 v1, v1, v253
    v_mul_f32 v2, v2, v253
    v_mul_f32 v3, v3, v253
    v_mul_f32 v4, v4, v253
    v_mul_f32 v5, v5, v253
    v_mul_f32 v6, v6, v253
    v_mul_f32 v7, v7, v253
    v_mul_f32 v8, v8, v253
    v_mul_f32 v9, v9, v253
    v_mul_f32 v10, v10, v253
    v_mul_f32 v11, v11, v253
    v_mul_f32 v12, v12, v253
    v_mul_f32 v13, v13, v253
    v_mul_f32 v14, v14, v253
    v_mul_f32 v15, v15, v253
    v_mul_f32 v16, v16, v253
    v_mul_f32 v17, v17, v253
    v_mul_f32 v18, v18, v253
    v_mul_f32 v19, v19, v253
    v_mul_f32 v20, v20, v253
    v_mul_f32 v21, v21, v253
    v_mul_f32 v22, v22, v253
    v_mul_f32 v23, v23, v253
    v_mul_f32 v24, v24, v253
    v_mul_f32 v25, v25, v253
    v_mul_f32 v26, v26, v253
    v_mul_f32 v27, v27, v253
    v_mul_f32 v28, v28, v253
    v_mul_f32 v29, v29, v253
    v_mul_f32 v30, v30, v253
    v_mul_f32 v31, v31, v253
    v_mul_f32 v32, v32, v253
    v_mul_f32 v33, v33, v253
    v_mul_f32 v34, v34, v253
    v_mul_f32 v35, v35, v253
    v_mul_f32 v36, v36, v253
    v_mul_f32 v37, v37, v253
    v_mul_f32 v38, v38, v253
    v_mul_f32 v39, v39, v253
    v_mul_f32 v40, v40, v253
    v_mul_f32 v41, v41, v253
    v_mul_f32 v42, v42, v253
    v_mul_f32 v43, v43, v253
    v_mul_f32 v44, v44, v253
    v_mul_f32 v45, v45, v253
    v_mul_f32 v46, v46, v253
    v_mul_f32 v47, v47, v253
    v_mul_f32 v48, v48, v253
    v_mul_f32 v49, v49, v253
    v_mul_f32 v50, v50, v253
    v_mul_f32 v51, v51, v253
    v_mul_f32 v52, v52, v253
    v_mul_f32 v53, v53, v253
    v_mul_f32 v54, v54, v253
    v_mul_f32 v55, v55, v253
    v_mul_f32 v56, v56, v253
    v_mul_f32 v57, v57, v253
    v_mul_f32 v58, v58, v253
    v_mul_f32 v59, v59, v253
    v_mul_f32 v60, v60, v253
    v_mul_f32 v61, v61, v253
    v_mul_f32 v62, v62, v253
    v_mul_f32 v63, v63, v253
    s_nop 1
    s_branch BACK_L1
RARE_L2:
    v_mov_b32 v253, v252
    s_nop 1
    v_permlane32_swap_b32 v252, v253
    v_max3_f32 v252, v252, v253, 0
    v_sub_f32 v253, 0, v252
    v_exp_f32 v253, v253
    v_sub_f32 v160, v160, v252
    v_sub_f32 v161, v161, v252
    v_sub_f32 v162, v162, v252
    v_sub_f32 v163, v163, v252
    v_sub_f32 v164, v164, v252
    v_sub_f32 v165, v165, v252
    v_sub_f32 v166, v166, v252
    v_sub_f32 v167, v167, v252
    v_sub_f32 v168, v168, v252
    v_sub_f32 v169, v169, v252
    v_sub_f32 v170, v170, v252
    v_sub_f32 v171, v171, v252
    v_sub_f32 v172, v172, v252
    v_sub_f32 v173, v173, v252
    v_sub_f32 v174, v174, v252
    v_sub_f32 v175, v175, v252
    v_sub_f32 v96, v96, v252
    v_sub_f32 v97, v97, v252
    v_sub_f32 v98, v98, v252
    v_sub_f32 v99, v99, v252
    v_sub_f32 v100, v100, v252
    v_sub_f32 v101, v101, v252
    v_sub_f32 v102, v102, v252
    v_sub_f32 v103, v103, v252
    v_sub_f32 v104, v104, v252
    v_sub_f32 v105, v105, v252
    v_sub_f32 v106, v106, v252
    v_sub_f32 v107, v107, v252
    v_sub_f32 v108, v108, v252
    v_sub_f32 v109, v109, v252
    v_sub_f32 v110, v110, v252
    v_sub_f32 v111, v111, v252
    v_sub_f32 v112, v112, v252
    v_sub_f32 v113, v113, v252
    v_sub_f32 v114, v114, v252
    v_sub_f32 v115, v115, v252
    v_sub_f32 v116, v116, v252
    v_sub_f32 v117, v117, v252
    v_sub_f32 v118, v118, v252
    v_sub_f32 v119, v119, v252
    v_sub_f32 v120, v120, v252
    v_sub_f32 v121, v121, v252
    v_sub_f32 v122, v122, v252
    v_sub_f32 v123, v123, v252
    v_sub_f32 v124, v124, v252
    v_sub_f32 v125, v125, v252
    v_sub_f32 v126, v126, v252
    v_sub_f32 v127, v127, v252
    v_mul_f32 v248, v248, v253
    v_mul_f32 v249, v249, v253
    v_mul_f32 v0, v0, v253
    v_mul_f32 v1, v1, v253
    v_mul_f32 v2, v2, v253
    v_mul_f32 v3, v3, v253
    v_mul_f32 v4, v4, v253
    v_mul_f32 v5, v5, v253
    v_mul_f32 v6, v6, v253
    v_mul_f32 v7, v7, v253
    v_mul_f32 v8, v8, v253
    v_mul_f32 v9, v9, v253
    v_mul_f32 v10, v10, v253
    v_mul_f32 v11, v11, v253
    v_mul_f32 v12, v12, v253
    v_mul_f32 v13, v13, v253
    v_mul_f32 v14, v14, v253
    v_mul_f32 v15, v15, v253
    v_mul_f32 v16, v16, v253
    v_mul_f32 v17, v17, v253
    v_mul_f32 v18, v18, v253
    v_mul_f32 v19, v19, v253
    v_mul_f32 v20, v20, v253
    v_mul_f32 v21, v21, v253
    v_mul_f32 v22, v22, v253
    v_mul_f32 v23, v23, v253
    v_mul_f32 v24, v24, v253
    v_mul_f32 v25, v25, v253
    v_mul_f32 v26, v26, v253
    v_mul_f32 v27, v27, v253
    v_mul_f32 v28, v28, v253
    v_mul_f32 v29, v29, v253
    v_mul_f32 v30, v30, v253
    v_mul_f32 v31, v31, v253
    v_mul_f32 v32, v32, v253
    v_mul_f32 v33, v33, v253
    v_mul_f32 v34, v34, v253
    v_mul_f32 v35, v35, v253
    v_mul_f32 v36, v36, v253
    v_mul_f32 v37, v37, v253
    v_mul_f32 v38, v38, v253
    v_mul_f32 v39, v39, v253
    v_mul_f32 v40, v40, v253
    v_mul_f32 v41, v41, v253
    v_mul_f32 v42, v42, v253
    v_mul_f32 v43, v43, v253
    v_mul_f32 v44, v44, v253
    v_mul_f32 v45, v45, v253
    v_mul_f32 v46, v46, v253
    v_mul_f32 v47, v47, v253
    v_mul_f32 v48, v48, v253
    v_mul_f32 v49, v49, v253
    v_mul_f32 v50, v50, v253
    v_mul_f32 v51, v51, v253
    v_mul_f32 v52, v52, v253
    v_mul_f32 v53, v53, v253
    v_mul_f32 v54, v54, v253
    v_mul_f32 v55, v55, v253
    v_mul_f32 v56, v56, v253
    v_mul_f32 v57, v57, v253
    v_mul_f32 v58, v58, v253
    v_mul_f32 v59, v59, v253
    v_mul_f32 v60, v60, v253
    v_mul_f32 v61, v61, v253
    v_mul_f32 v62, v62, v253
    v_mul_f32 v63, v63, v253
    s_nop 1
    s_branch BACK_L2
RARE_L3:
    v_mov_b32 v253, v252
    s_nop 1
    v_permlane32_swap_b32 v252, v253
    v_max3_f32 v252, v252, v253, 0
    v_sub_f32 v253, 0, v252
    v_exp_f32 v253, v253
    v_sub_f32 v160, v160, v252
    v_sub_f32 v161, v161, v252
    v_sub_f32 v162, v162, v252
    v_sub_f32 v163, v163, v252
    v_sub_f32 v164, v164, v252
    v_sub_f32 v165, v165, v252
    v_sub_f32 v166, v166, v252
    v_sub_f32 v167, v167, v252
    v_sub_f32 v168, v168, v252
    v_sub_f32 v169, v169, v252
    v_sub_f32 v170, v170, v252
    v_sub_f32 v171, v171, v252
    v_sub_f32 v172, v172, v252
    v_sub_f32 v173, v173, v252
    v_sub_f32 v174, v174, v252
    v_sub_f32 v175, v175, v252
    v_sub_f32 v128, v128, v252
    v_sub_f32 v129, v129, v252
    v_sub_f32 v130, v130, v252
    v_sub_f32 v131, v131, v252
    v_sub_f32 v132, v132, v252
    v_sub_f32 v133, v133, v252
    v_sub_f32 v134, v134, v252
    v_sub_f32 v135, v135, v252
    v_sub_f32 v136, v136, v252
    v_sub_f32 v137, v137, v252
    v_sub_f32 v138, v138, v252
    v_sub_f32 v139, v139, v252
    v_sub_f32 v140, v140, v252
    v_sub_f32 v141, v141, v252
    v_sub_f32 v142, v142, v252
    v_sub_f32 v143, v143, v252
    v_sub_f32 v144, v144, v252
    v_sub_f32 v145, v145, v252
    v_sub_f32 v146, v146, v252
    v_sub_f32 v147, v147, v252
    v_sub_f32 v148, v148, v252
    v_sub_f32 v149, v149, v252
    v_sub_f32 v150, v150, v252
    v_sub_f32 v151, v151, v252
    v_sub_f32 v152, v152, v252
    v_sub_f32 v153, v153, v252
    v_sub_f32 v154, v154, v252
    v_sub_f32 v155, v155, v252
    v_sub_f32 v156, v156, v252
    v_sub_f32 v157, v157, v252
    v_sub_f32 v158, v158, v252
    v_sub_f32 v159, v159, v252
    v_mul_f32 v248, v248, v253
    v_mul_f32 v249, v249, v253
    v_mul_f32 v0, v0, v253
    v_mul_f32 v1, v1, v253
    v_mul_f32 v2, v2, v253
    v_mul_f32 v3, v3, v253
    v_mul_f32 v4, v4, v253
    v_mul_f32 v5, v5, v253
    v_mul_f32 v6, v6, v253
    v_mul_f32 v7, v7, v253
    v_mul_f32 v8, v8, v253
    v_mul_f32 v9, v9, v253
    v_mul_f32 v10, v10, v253
    v_mul_f32 v11, v11, v253
    v_mul_f32 v12, v12, v253
    v_mul_f32 v13, v13, v253
    v_mul_f32 v14, v14, v253
    v_mul_f32 v15, v15, v253
    v_mul_f32 v16, v16, v253
    v_mul_f32 v17, v17, v253
    v_mul_f32 v18, v18, v253
    v_mul_f32 v19, v19, v253
    v_mul_f32 v20, v20, v253
    v_mul_f32 v21, v21, v253
    v_mul_f32 v22, v22, v253
    v_mul_f32 v23, v23, v253
    v_mul_f32 v24, v24, v253
    v_mul_f32 v25, v25, v253
    v_mul_f32 v26, v26, v253
    v_mul_f32 v27, v27, v253
    v_mul_f32 v28, v28, v253
    v_mul_f32 v29, v29, v253
    v_mul_f32 v30, v30, v253
    v_mul_f32 v31, v31, v253
    v_mul_f32 v32, v32, v253
    v_mul_f32 v33, v33, v253
    v_mul_f32 v34, v34, v253
    v_mul_f32 v35, v35, v253
    v_mul_f32 v36, v36, v253
    v_mul_f32 v37, v37, v253
    v_mul_f32 v38, v38, v253
    v_mul_f32 v39, v39, v253
    v_mul_f32 v40, v40, v253
    v_mul_f32 v41, v41, v253
    v_mul_f32 v42, v42, v253
    v_mul_f32 v43, v43, v253
    v_mul_f32 v44, v44, v253
    v_mul_f32 v45, v45, v253
    v_mul_f32 v46, v46, v253
    v_mul_f32 v47, v47, v253
    v_mul_f32 v48, v48, v253
    v_mul_f32 v49, v49, v253
    v_mul_f32 v50, v50, v253
    v_mul_f32 v51, v51, v253
    v_mul_f32 v52, v52, v253
    v_mul_f32 v53, v53, v253
    v_mul_f32 v54, v54, v253
    v_mul_f32 v55, v55, v253
    v_mul_f32 v56, v56, v253
    v_mul_f32 v57, v57, v253
    v_mul_f32 v58, v58, v253
    v_mul_f32 v59, v59, v253
    v_mul_f32 v60, v60, v253
    v_mul_f32 v61, v61, v253
    v_mul_f32 v62, v62, v253
    v_mul_f32 v63, v63, v253
    s_nop 1
    s_branch BACK_L3
K1_LOADER:
    s_sub_u32 s40, s14, 4
    s_lshl_b32 s41, s40, 12
    s_mov_b32 s45, 0
    s_mov_b32 s48, 0
    s_lshl_b32 s42, s15, 18
    s_add_u32 s20, s4, s42
    s_addc_u32 s21, s5, 0
    s_mov_b32 s22, 0x40000
    s_mov_b32 s23, 0x20000
    s_lshl_b32 s42, s16, 8
    s_add_u32 s24, s10, s42
    s_addc_u32 s25, s11, 0
    s_sub_u32 s26, 0x800000, s42
    s_mov_b32 s27, 0x20000
    v_lshrrev_b32 v1, 4, v0
    v_and_b32 v2, 15, v0
    v_lshrrev_b32 v3, 3, v0
    v_and_b32 v4, 7, v0
    v_lshlrev_b32 v5, 2, v1
    v_xor_b32 v5, v5, v2
    v_lshlrev_b32 v6, 4, v5
    s_lshl_b32 s42, s40, 5
    v_add_u32 v5, 0, v1
    v_xor_b32 v5, v5, v4
    v_lshlrev_b32 v5, 4, v5
    v_add_u32 v7, s42, v3
    v_add_u32 v7, 0, v7
    v_lshl_add_u32 v5, v7, 11, v5
    v_mov_b32 v20, v5
    v_add_u32 v5, 4, v1
    v_xor_b32 v5, v5, v4
    v_lshlrev_b32 v5, 4, v5
    v_add_u32 v7, s42, v3
    v_add_u32 v7, 8, v7
    v_lshl_add_u32 v5, v7, 11, v5
    v_subrev_u32 v21, 1024, v5
    v_add_u32 v5, 0, v1
    v_xor_b32 v5, v5, v4
    v_lshlrev_b32 v5, 4, v5
    v_add_u32 v7, s42, v3
    v_add_u32 v7, 16, v7
    v_lshl_add_u32 v5, v7, 11, v5
    v_subrev_u32 v22, 2048, v5
    v_add_u32 v5, 4, v1
    v_xor_b32 v5, v5, v4
    v_lshlrev_b32 v5, 4, v5
    v_add_u32 v7, s42, v3
    v_add_u32 v7, 24, v7
    v_lshl_add_u32 v5, v7, 11, v5
    v_subrev_u32 v23, 3072, v5
    s_lshl_b32 s42, s40, 4
    v_add_u32 v5, s42, v1
    v_add_u32 v5, 0, v5
    v_xor_b32 v8, 0, v6
    v_lshl_add_u32 v7, v5, 13, v8
    v_lshl_add_u32 v5, v5, 11, v8
    v_subrev_u32 v16, 0, v7
    v_subrev_u32 v24, 0, v5
    v_add_u32 v5, s42, v1
    v_add_u32 v5, 4, v5
    v_xor_b32 v8, 0, v6
    v_lshl_add_u32 v7, v5, 13, v8
    v_lshl_add_u32 v5, v5, 11, v8
    v_subrev_u32 v17, 1024, v7
    v_subrev_u32 v25, 1024, v5
    v_add_u32 v5, s42, v1
    v_add_u32 v5, 8, v5
    v_xor_b32 v8, 32, v6
    v_lshl_add_u32 v7, v5, 13, v8
    v_lshl_add_u32 v5, v5, 11, v8
    v_subrev_u32 v18, 2048, v7
    v_subrev_u32 v26, 2048, v5
    v_add_u32 v5, s42, v1
    v_add_u32 v5, 12, v5
    v_xor_b32 v8, 32, v6
    v_lshl_add_u32 v7, v5, 13, v8
    v_lshl_add_u32 v5, v5, 11, v8
    v_subrev_u32 v19, 3072, v7
    v_subrev_u32 v27, 3072, v5
    s_lshl_b32 s52, s19, 1
    s_and_b32 s53, s15, 3
    s_lshl_b32 s53, s53, 2
    s_add_u32 s52, s52, s53
    v_mov_b32 v9, 147456
    s_lshl_b32 s42, s40, 2
    v_add_u32 v8, s42, v9
    s_lshl_b32 s42, s17, 18
    s_add_u32 s28, s6, s42
    s_addc_u32 s29, s7, 0
    s_mov_b32 s30, 0x40000
    s_mov_b32 s31, 0x20000
    s_add_u32 s32, s8, s42
    s_addc_u32 s33, s9, 0
    s_mov_b32 s34, 0x40000
    s_mov_b32 s35, 0x20000
    v_add_u32 v5, 0, v1
    v_xor_b32 v5, v5, v2
    v_lshlrev_b32 v5, 4, v5
    v_lshl_add_u32 v5, v1, 8, v5
    v_add_u32 v10, s41, v5
    v_add_u32 v5, 4, v1
    v_xor_b32 v5, v5, v2
    v_lshlrev_b32 v5, 4, v5
    v_lshl_add_u32 v5, v1, 8, v5
    v_add_u32 v11, s41, v5
    v_add_u32 v5, 8, v1
    v_xor_b32 v5, v5, v2
    v_lshlrev_b32 v5, 4, v5
    v_lshl_add_u32 v5, v1, 8, v5
    v_add_u32 v12, s41, v5
    v_add_u32 v5, 12, v1
    v_xor_b32 v5, v5, v2
    v_lshlrev_b32 v5, 4, v5
    v_lshl_add_u32 v5, v1, 8, v5
    v_add_u32 v13, s41, v5
    v_lshl_add_u32 v5, v1, 8, v6
    v_add_u32 v14, s41, v5
    v_lshlrev_b32 v5, 4, v0
    v_add_u32 v15, s41, v5
    s_lshl_b32 s42, s18, 21
    s_lshl_b32 s43, s19, 8
    s_add_u32 s42, s42, s43
    s_add_u32 s80, s68, s42
    s_addc_u32 s81, s69, 0
    s_sub_u32 s82, 0x800000, s42
    s_mov_b32 s83, 0x20000
    s_lshl_b32 s54, s19, 1
    s_lshl_b32 s55, s18, 3
    s_lshl_b32 s42, s15, 5
    s_add_u32 s55, s55, s42
    s_lshl_b32 s55, s55, 15
    v_add_u32 v3, 65536, v15
    s_mov_b32 s50, 0
    s_and_b32 s47, s50, 3
    s_lshl_b32 s47, s47, 14
    s_add_u32 s47, s47, s41
    s_add_u32 s44, s52, s50
    s_and_b32 s44, s44, 15
    s_mov_b32 m0, s47
    s_lshl_b32 s43, s44, 7
    buffer_load_dwordx4 v20, s[20:23], s43 offen offset:0 lds
    buffer_load_dwordx4 v21, s[20:23], s43 offen offset:1024 lds
    buffer_load_dwordx4 v22, s[20:23], s43 offen offset:2048 lds
    buffer_load_dwordx4 v23, s[20:23], s43 offen offset:3072 lds
    s_add_u32 m0, s47, 65536
    s_lshl_b32 s43, s44, 19
    buffer_load_dwordx4 v16, s[24:27], s43 offen offset:0 lds
    buffer_load_dwordx4 v17, s[24:27], s43 offen offset:1024 lds
    buffer_load_dwordx4 v18, s[24:27], s43 offen offset:2048 lds
    buffer_load_dwordx4 v19, s[24:27], s43 offen offset:3072 lds
    s_mov_b32 s50, 1
    s_and_b32 s47, s50, 3
    s_lshl_b32 s47, s47, 14
    s_add_u32 s47, s47, s41
    s_add_u32 s44, s52, s50
    s_and_b32 s44, s44, 15
    s_mov_b32 m0, s47
    s_lshl_b32 s43, s44, 7
    buffer_load_dwordx4 v20, s[20:23], s43 offen offset:0 lds
    buffer_load_dwordx4 v21, s[20:23], s43 offen offset:1024 lds
    buffer_load_dwordx4 v22, s[20:23], s43 offen offset:2048 lds
    buffer_load_dwordx4 v23, s[20:23], s43 offen offset:3072 lds
    s_add_u32 m0, s47, 65536
    s_lshl_b32 s43, s44, 19
    buffer_load_dwordx4 v16, s[24:27], s43 offen offset:0 lds
    buffer_load_dwordx4 v17, s[24:27], s43 offen offset:1024 lds
    buffer_load_dwordx4 v18, s[24:27], s43 offen offset:2048 lds
    buffer_load_dwordx4 v19, s[24:27], s43 offen offset:3072 lds
    s_waitcnt vmcnt(8)
    s_barrier
    s_mov_b32 s50, 2
    s_and_b32 s47, s50, 3
    s_lshl_b32 s47, s47, 14
    s_add_u32 s47, s47, s41
    s_add_u32 s44, s52, s50
    s_and_b32 s44, s44, 15
    s_mov_b32 m0, s47
    s_lshl_b32 s43, s44, 7
    buffer_load_dwordx4 v20, s[20:23], s43 offen offset:0 lds
    buffer_load_dwordx4 v21, s[20:23], s43 offen offset:1024 lds
    buffer_load_dwordx4 v22, s[20:23], s43 offen offset:2048 lds
    buffer_load_dwordx4 v23, s[20:23], s43 offen offset:3072 lds
    s_add_u32 m0, s47, 65536
    s_lshl_b32 s43, s44, 19
    buffer_load_dwordx4 v16, s[24:27], s43 offen offset:0 lds
    buffer_load_dwordx4 v17, s[24:27], s43 offen offset:1024 lds
    buffer_load_dwordx4 v18, s[24:27], s43 offen offset:2048 lds
    buffer_load_dwordx4 v19, s[24:27], s43 offen offset:3072 lds
    s_waitcnt vmcnt(8)
    s_barrier
    s_mov_b32 s50, 3
    s_and_b32 s47, s50, 3
    s_lshl_b32 s47, s47, 14
    s_add_u32 s47, s47, s41
    s_add_u32 s44, s52, s50
    s_and_b32 s44, s44, 15
    s_mov_b32 m0, s47
    s_lshl_b32 s43, s44, 7
    buffer_load_dwordx4 v20, s[20:23], s43 offen offset:0 lds
    buffer_load_dwordx4 v21, s[20:23], s43 offen offset:1024 lds
    buffer_load_dwordx4 v22, s[20:23], s43 offen offset:2048 lds
    buffer_load_dwordx4 v23, s[20:23], s43 offen offset:3072 lds
    s_add_u32 m0, s47, 65536
    s_lshl_b32 s43, s44, 19
    buffer_load_dwordx4 v16, s[24:27], s43 offen offset:0 lds
    buffer_load_dwordx4 v17, s[24:27], s43 offen offset:1024 lds
    buffer_load_dwordx4 v18, s[24:27], s43 offen offset:2048 lds
    buffer_load_dwordx4 v19, s[24:27], s43 offen offset:3072 lds
    s_mov_b32 s50, 4
    s_and_b32 s47, s50, 3
    s_lshl_b32 s47, s47, 14
    s_add_u32 s47, s47, s41
    s_add_u32 s44, s52, s50
    s_and_b32 s44, s44, 15
    s_mov_b32 m0, s47
    s_lshl_b32 s43, s44, 7
    buffer_load_dwordx4 v20, s[20:23], s43 offen offset:0 lds
    buffer_load_dwordx4 v21, s[20:23], s43 offen offset:1024 lds
    buffer_load_dwordx4 v22, s[20:23], s43 offen offset:2048 lds
    buffer_load_dwordx4 v23, s[20:23], s43 offen offset:3072 lds
    s_add_u32 m0, s47, 65536
    s_lshl_b32 s43, s44, 19
    buffer_load_dwordx4 v16, s[24:27], s43 offen offset:0 lds
    buffer_load_dwordx4 v17, s[24:27], s43 offen offset:1024 lds
    buffer_load_dwordx4 v18, s[24:27], s43 offen offset:2048 lds
    buffer_load_dwordx4 v19, s[24:27], s43 offen offset:3072 lds
    s_mov_b32 s50, 5
LA:
    s_waitcnt vmcnt(16)
    s_barrier
    s_and_b32 s47, s50, 3
    s_lshl_b32 s47, s47, 14
    s_add_u32 s47, s47, s41
    s_add_u32 s44, s52, s50
    s_and_b32 s44, s44, 15
    s_mov_b32 m0, s47
    s_lshl_b32 s43, s44, 7
    buffer_load_dwordx4 v20, s[20:23], s43 offen offset:0 lds
    buffer_load_dwordx4 v21, s[20:23], s43 offen offset:1024 lds
    buffer_load_dwordx4 v22, s[20:23], s43 offen offset:2048 lds
    buffer_load_dwordx4 v23, s[20:23], s43 offen offset:3072 lds
    s_add_u32 m0, s47, 65536
    s_lshl_b32 s43, s44, 19
    buffer_load_dwordx4 v16, s[24:27], s43 offen offset:0 lds
    buffer_load_dwordx4 v17, s[24:27], s43 offen offset:1024 lds
    buffer_load_dwordx4 v18, s[24:27], s43 offen offset:2048 lds
    buffer_load_dwordx4 v19, s[24:27], s43 offen offset:3072 lds
    s_add_u32 s50, s50, 1
    s_cmp_lt_u32 s50, 16
    s_cbranch_scc1 LA
    s_and_b32 s56, s15, 3
    s_lshl_b32 s56, s56, 2
    s_add_u32 s56, s56, s54
    s_add_u32 s56, s56, 2
    v_mov_b32 v7, 0
    s_cmp_lg_u32 s2, 0
    s_cbranch_scc1 NONONCE
    s_cmp_lg_u32 s14, 7
    s_cbranch_scc1 NONONCE
    s_memrealtime s[46:47]
    s_waitcnt lgkmcnt(0)
    s_or_b32 s46, s46, 1
    v_mov_b32 v4, s46
    v_mov_b32 v5, s47
    v_mov_b32 v7, 0
    s_mov_b64 exec, 1
    buffer_store_dwordx2 v[4:5], v7, s[76:79], 0 offen sc1
    s_mov_b64 exec, -1
    s_waitcnt vmcnt(0)
NONONCE:
    s_lshr_b32 s95, s2, 3
    s_add_u32 s95, s95, s2
    s_and_b32 s95, s95, 7
    s_add_u32 s95, s95, 18
    s_and_b32 s57, s15, 3
    s_lshl_b32 s57, s57, 2
    s_add_u32 s57, s57, s54
    s_waitcnt vmcnt(16)
    s_barrier
    s_add_u32 m0, s41, 0
    s_mov_b32 s43, 0
    buffer_load_dwordx4 v10, s[28:31], s43 offen offset:0 nt lds
    buffer_load_dwordx4 v11, s[28:31], s43 offen offset:1024 nt lds
    buffer_load_dwordx4 v12, s[28:31], s43 offen offset:2048 nt lds
    buffer_load_dwordx4 v13, s[28:31], s43 offen offset:3072 nt lds
    s_waitcnt vmcnt(12)
    s_barrier
    s_add_u32 m0, s41, 16384
    s_mov_b32 s43, 16384
    buffer_load_dwordx4 v10, s[28:31], s43 offen offset:0 nt lds
    buffer_load_dwordx4 v11, s[28:31], s43 offen offset:1024 nt lds
    buffer_load_dwordx4 v12, s[28:31], s43 offen offset:2048 nt lds
    buffer_load_dwordx4 v13, s[28:31], s43 offen offset:3072 nt lds
    s_add_u32 m0, s41, 65536
    s_mov_b32 s43, 0
    buffer_load_dwordx4 v14, s[32:35], s43 offen offset:0 nt lds
    buffer_load_dwordx4 v14, s[32:35], s43 offen offset:1024 nt lds
    buffer_load_dwordx4 v14, s[32:35], s43 offen offset:2048 nt lds
    buffer_load_dwordx4 v14, s[32:35], s43 offen offset:3072 nt lds
    s_waitcnt vmcnt(12)
    s_barrier
    s_add_u32 m0, s41, 32768
    s_mov_b32 s43, 32768
    buffer_load_dwordx4 v10, s[28:31], s43 offen offset:0 nt lds
    buffer_load_dwordx4 v11, s[28:31], s43 offen offset:1024 nt lds
    buffer_load_dwordx4 v12, s[28:31], s43 offen offset:2048 nt lds
    buffer_load_dwordx4 v13, s[28:31], s43 offen offset:3072 nt lds
    s_waitcnt vmcnt(12)
    s_barrier
    s_waitcnt vmcnt(8)
    s_add_u32 m0, s41, 81920
    s_mov_b32 s43, 16384
    buffer_load_dwordx4 v14, s[32:35], s43 offen offset:0 nt lds
    buffer_load_dwordx4 v14, s[32:35], s43 offen offset:1024 nt lds
    buffer_load_dwordx4 v14, s[32:35], s43 offen offset:2048 nt lds
    buffer_load_dwordx4 v14, s[32:35], s43 offen offset:3072 nt lds
    s_waitcnt vmcnt(8)
    s_add_u32 m0, s41, 49152
    s_mov_b32 s43, 49152
    buffer_load_dwordx4 v10, s[28:31], s43 offen offset:0 nt lds
    buffer_load_dwordx4 v11, s[28:31], s43 offen offset:1024 nt lds
    buffer_load_dwordx4 v12, s[28:31], s43 offen offset:2048 nt lds
    buffer_load_dwordx4 v13, s[28:31], s43 offen offset:3072 nt lds
    s_barrier
    s_waitcnt vmcnt(8)
    s_add_u32 m0, s41, 98304
    s_mov_b32 s43, 32768
    buffer_load_dwordx4 v14, s[32:35], s43 offen offset:0 nt lds
    buffer_load_dwordx4 v14, s[32:35], s43 offen offset:1024 nt lds
    buffer_load_dwordx4 v14, s[32:35], s43 offen offset:2048 nt lds
    buffer_load_dwordx4 v14, s[32:35], s43 offen offset:3072 nt lds
    s_waitcnt vmcnt(8)
    s_add_u32 m0, s41, 0
    s_mov_b32 s43, 65536
    buffer_load_dwordx4 v10, s[28:31], s43 offen offset:0 nt lds
    buffer_load_dwordx4 v11, s[28:31], s43 offen offset:1024 nt lds
    buffer_load_dwordx4 v12, s[28:31], s43 offen offset:2048 nt lds
    buffer_load_dwordx4 v13, s[28:31], s43 offen offset:3072 nt lds
    s_barrier
    s_waitcnt vmcnt(8)
    s_add_u32 m0, s41, 114688
    s_mov_b32 s43, 49152
    buffer_load_dwordx4 v14, s[32:35], s43 offen offset:0 nt lds
    buffer_load_dwordx4 v14, s[32:35], s43 offen offset:1024 nt lds
    buffer_load_dwordx4 v14, s[32:35], s43 offen offset:2048 nt lds
    buffer_load_dwordx4 v14, s[32:35], s43 offen offset:3072 nt lds
    s_waitcnt vmcnt(8)
    s_add_u32 m0, s41, 16384
    s_mov_b32 s43, 81920
    buffer_load_dwordx4 v10, s[28:31], s43 offen offset:0 nt lds
    buffer_load_dwordx4 v11, s[28:31], s43 offen offset:1024 nt lds
    buffer_load_dwordx4 v12, s[28:31], s43 offen offset:2048 nt lds
    buffer_load_dwordx4 v13, s[28:31], s43 offen offset:3072 nt lds
    s_barrier
    s_waitcnt vmcnt(8)
    s_add_u32 m0, s41, 65536
    s_mov_b32 s43, 65536
    buffer_load_dwordx4 v14, s[32:35], s43 offen offset:0 nt lds
    buffer_load_dwordx4 v14, s[32:35], s43 offen offset:1024 nt lds
    buffer_load_dwordx4 v14, s[32:35], s43 offen offset:2048 nt lds
    buffer_load_dwordx4 v14, s[32:35], s43 offen offset:3072 nt lds
    s_waitcnt vmcnt(8)
    s_add_u32 m0, s41, 32768
    s_mov_b32 s43, 98304
    buffer_load_dwordx4 v10, s[28:31], s43 offen offset:0 nt lds
    buffer_load_dwordx4 v11, s[28:31], s43 offen offset:1024 nt lds
    buffer_load_dwordx4 v12, s[28:31], s43 offen offset:2048 nt lds
    buffer_load_dwordx4 v13, s[28:31], s43 offen offset:3072 nt lds
    s_barrier
    s_waitcnt vmcnt(8)
    s_add_u32 m0, s41, 81920
    s_mov_b32 s43, 81920
    buffer_load_dwordx4 v14, s[32:35], s43 offen offset:0 nt lds
    buffer_load_dwordx4 v14, s[32:35], s43 offen offset:1024 nt lds
    buffer_load_dwordx4 v14, s[32:35], s43 offen offset:2048 nt lds
    buffer_load_dwordx4 v14, s[32:35], s43 offen offset:3072 nt lds
    s_waitcnt vmcnt(8)
    s_add_u32 m0, s41, 49152
    s_mov_b32 s43, 114688
    buffer_load_dwordx4 v10, s[28:31], s43 offen offset:0 nt lds
    buffer_load_dwordx4 v11, s[28:31], s43 offen offset:1024 nt lds
    buffer_load_dwordx4 v12, s[28:31], s43 offen offset:2048 nt lds
    buffer_load_dwordx4 v13, s[28:31], s43 offen offset:3072 nt lds
    s_barrier
    s_waitcnt vmcnt(8)
    s_add_u32 m0, s41, 98304
    s_mov_b32 s43, 98304
    buffer_load_dwordx4 v14, s[32:35], s43 offen offset:0 nt lds
    buffer_load_dwordx4 v14, s[32:35], s43 offen offset:1024 nt lds
    buffer_load_dwordx4 v14, s[32:35], s43 offen offset:2048 nt lds
    buffer_load_dwordx4 v14, s[32:35], s43 offen offset:3072 nt lds
    s_waitcnt vmcnt(8)
    s_add_u32 m0, s41, 0
    s_mov_b32 s43, 131072
    buffer_load_dwordx4 v10, s[28:31], s43 offen offset:0 nt lds
    buffer_load_dwordx4 v11, s[28:31], s43 offen offset:1024 nt lds
    buffer_load_dwordx4 v12, s[28:31], s43 offen offset:2048 nt lds
    buffer_load_dwordx4 v13, s[28:31], s43 offen offset:3072 nt lds
    s_barrier
    s_waitcnt vmcnt(8)
    s_add_u32 m0, s41, 114688
    s_mov_b32 s43, 114688
    buffer_load_dwordx4 v14, s[32:35], s43 offen offset:0 nt lds
    buffer_load_dwordx4 v14, s[32:35], s43 offen offset:1024 nt lds
    buffer_load_dwordx4 v14, s[32:35], s43 offen offset:2048 nt lds
    buffer_load_dwordx4 v14, s[32:35], s43 offen offset:3072 nt lds
    s_waitcnt vmcnt(8)
    s_add_u32 m0, s41, 16384
    s_mov_b32 s43, 147456
    buffer_load_dwordx4 v10, s[28:31], s43 offen offset:0 nt lds
    buffer_load_dwordx4 v11, s[28:31], s43 offen offset:1024 nt lds
    buffer_load_dwordx4 v12, s[28:31], s43 offen offset:2048 nt lds
    buffer_load_dwordx4 v13, s[28:31], s43 offen offset:3072 nt lds
    s_barrier
    s_waitcnt vmcnt(8)
    s_add_u32 m0, s41, 65536
    s_mov_b32 s43, 131072
    buffer_load_dwordx4 v14, s[32:35], s43 offen offset:0 nt lds
    buffer_load_dwordx4 v14, s[32:35], s43 offen offset:1024 nt lds
    buffer_load_dwordx4 v14, s[32:35], s43 offen offset:2048 nt lds
    buffer_load_dwordx4 v14, s[32:35], s43 offen offset:3072 nt lds
    s_waitcnt vmcnt(8)
    s_add_u32 m0, s41, 32768
    s_mov_b32 s43, 163840
    buffer_load_dwordx4 v10, s[28:31], s43 offen offset:0 nt lds
    buffer_load_dwordx4 v11, s[28:31], s43 offen offset:1024 nt lds
    buffer_load_dwordx4 v12, s[28:31], s43 offen offset:2048 nt lds
    buffer_load_dwordx4 v13, s[28:31], s43 offen offset:3072 nt lds
    s_barrier
    s_waitcnt vmcnt(8)
    s_add_u32 m0, s41, 81920
    s_mov_b32 s43, 147456
    buffer_load_dwordx4 v14, s[32:35], s43 offen offset:0 nt lds
    buffer_load_dwordx4 v14, s[32:35], s43 offen offset:1024 nt lds
    buffer_load_dwordx4 v14, s[32:35], s43 offen offset:2048 nt lds
    buffer_load_dwordx4 v14, s[32:35], s43 offen offset:3072 nt lds
    s_waitcnt vmcnt(8)
    s_add_u32 m0, s41, 49152
    s_mov_b32 s43, 180224
    buffer_load_dwordx4 v10, s[28:31], s43 offen offset:0 nt lds
    buffer_load_dwordx4 v11, s[28:31], s43 offen offset:1024 nt lds
    buffer_load_dwordx4 v12, s[28:31], s43 offen offset:2048 nt lds
    buffer_load_dwordx4 v13, s[28:31], s43 offen offset:3072 nt lds
    s_barrier
    s_waitcnt vmcnt(8)
    s_add_u32 m0, s41, 98304
    s_mov_b32 s43, 163840
    buffer_load_dwordx4 v14, s[32:35], s43 offen offset:0 nt lds
    buffer_load_dwordx4 v14, s[32:35], s43 offen offset:1024 nt lds
    buffer_load_dwordx4 v14, s[32:35], s43 offen offset:2048 nt lds
    buffer_load_dwordx4 v14, s[32:35], s43 offen offset:3072 nt lds
    s_waitcnt vmcnt(8)
    s_add_u32 m0, s41, 0
    s_mov_b32 s43, 196608
    buffer_load_dwordx4 v10, s[28:31], s43 offen offset:0 nt lds
    buffer_load_dwordx4 v11, s[28:31], s43 offen offset:1024 nt lds
    buffer_load_dwordx4 v12, s[28:31], s43 offen offset:2048 nt lds
    buffer_load_dwordx4 v13, s[28:31], s43 offen offset:3072 nt lds
    s_barrier
    s_waitcnt vmcnt(8)
    s_add_u32 m0, s41, 114688
    s_mov_b32 s43, 180224
    buffer_load_dwordx4 v14, s[32:35], s43 offen offset:0 nt lds
    buffer_load_dwordx4 v14, s[32:35], s43 offen offset:1024 nt lds
    buffer_load_dwordx4 v14, s[32:35], s43 offen offset:2048 nt lds
    buffer_load_dwordx4 v14, s[32:35], s43 offen offset:3072 nt lds
    s_waitcnt vmcnt(8)
    s_add_u32 m0, s41, 16384
    s_mov_b32 s43, 212992
    buffer_load_dwordx4 v10, s[28:31], s43 offen offset:0 nt lds
    buffer_load_dwordx4 v11, s[28:31], s43 offen offset:1024 nt lds
    buffer_load_dwordx4 v12, s[28:31], s43 offen offset:2048 nt lds
    buffer_load_dwordx4 v13, s[28:31], s43 offen offset:3072 nt lds
    s_barrier
    s_waitcnt vmcnt(8)
    s_add_u32 m0, s41, 65536
    s_mov_b32 s43, 196608
    buffer_load_dwordx4 v14, s[32:35], s43 offen offset:0 nt lds
    buffer_load_dwordx4 v14, s[32:35], s43 offen offset:1024 nt lds
    buffer_load_dwordx4 v14, s[32:35], s43 offen offset:2048 nt lds
    buffer_load_dwordx4 v14, s[32:35], s43 offen offset:3072 nt lds
    s_waitcnt vmcnt(8)
    s_add_u32 m0, s41, 32768
    s_mov_b32 s43, 229376
    buffer_load_dwordx4 v10, s[28:31], s43 offen offset:0 nt lds
    buffer_load_dwordx4 v11, s[28:31], s43 offen offset:1024 nt lds
    buffer_load_dwordx4 v12, s[28:31], s43 offen offset:2048 nt lds
    buffer_load_dwordx4 v13, s[28:31], s43 offen offset:3072 nt lds
    s_barrier
    s_waitcnt vmcnt(8)
    s_add_u32 m0, s41, 81920
    s_mov_b32 s43, 212992
    buffer_load_dwordx4 v14, s[32:35], s43 offen offset:0 nt lds
    buffer_load_dwordx4 v14, s[32:35], s43 offen offset:1024 nt lds
    buffer_load_dwordx4 v14, s[32:35], s43 offen offset:2048 nt lds
    buffer_load_dwordx4 v14, s[32:35], s43 offen offset:3072 nt lds
    s_waitcnt vmcnt(8)
    s_add_u32 m0, s41, 49152
    s_mov_b32 s43, 245760
    buffer_load_dwordx4 v10, s[28:31], s43 offen offset:0 nt lds
    buffer_load_dwordx4 v11, s[28:31], s43 offen offset:1024 nt lds
    buffer_load_dwordx4 v12, s[28:31], s43 offen offset:2048 nt lds
    buffer_load_dwordx4 v13, s[28:31], s43 offen offset:3072 nt lds
    s_barrier
    s_waitcnt vmcnt(8)
    s_add_u32 m0, s41, 98304
    s_mov_b32 s43, 229376
    buffer_load_dwordx4 v14, s[32:35], s43 offen offset:0 nt lds
    buffer_load_dwordx4 v14, s[32:35], s43 offen offset:1024 nt lds
    buffer_load_dwordx4 v14, s[32:35], s43 offen offset:2048 nt lds
    buffer_load_dwordx4 v14, s[32:35], s43 offen offset:3072 nt lds
    s_waitcnt vmcnt(8)
    s_add_u32 m0, s41, 114688
    s_mov_b32 s43, 245760
    buffer_load_dwordx4 v14, s[32:35], s43 offen offset:0 nt lds
    buffer_load_dwordx4 v14, s[32:35], s43 offen offset:1024 nt lds
    buffer_load_dwordx4 v14, s[32:35], s43 offen offset:2048 nt lds
    buffer_load_dwordx4 v14, s[32:35], s43 offen offset:3072 nt lds
    s_barrier
    s_waitcnt vmcnt(8)
    buffer_load_dwordx2 v[28:29], v7, s[76:79], 0 offen sc1
    s_add_u32 s43, s56, 0
    s_and_b32 s43, s43, 15
    s_lshl_b32 s43, s43, 17
    buffer_load_dwordx4 v[32:35], v24, s[80:83], s43 offen offset:0
    buffer_load_dwordx4 v[36:39], v25, s[80:83], s43 offen offset:1024
    buffer_load_dwordx4 v[40:43], v26, s[80:83], s43 offen offset:2048
    buffer_load_dwordx4 v[44:47], v27, s[80:83], s43 offen offset:3072
    s_waitcnt vmcnt(8)
    s_add_u32 m0, s41, 65536
    s_add_u32 s43, s54, 0
    s_and_b32 s43, s43, 15
    s_lshl_b32 s43, s43, 17
    buffer_load_dwordx4 v24, s[80:83], s43 offen offset:0 lds
    buffer_load_dwordx4 v25, s[80:83], s43 offen offset:1024 lds
    buffer_load_dwordx4 v26, s[80:83], s43 offen offset:2048 lds
    buffer_load_dwordx4 v27, s[80:83], s43 offen offset:3072 lds
    s_barrier
    s_waitcnt vmcnt(8)
    s_add_u32 s43, s56, 1
    s_and_b32 s43, s43, 15
    s_lshl_b32 s43, s43, 17
    buffer_load_dwordx4 v[48:51], v24, s[80:83], s43 offen offset:0
    buffer_load_dwordx4 v[52:55], v25, s[80:83], s43 offen offset:1024
    buffer_load_dwordx4 v[56:59], v26, s[80:83], s43 offen offset:2048
    buffer_load_dwordx4 v[60:63], v27, s[80:83], s43 offen offset:3072
    s_barrier
    s_add_u32 m0, s41, 81920
    s_add_u32 s43, s54, 1
    s_and_b32 s43, s43, 15
    s_lshl_b32 s43, s43, 17
    buffer_load_dwordx4 v24, s[80:83], s43 offen offset:0 lds
    buffer_load_dwordx4 v25, s[80:83], s43 offen offset:1024 lds
    buffer_load_dwordx4 v26, s[80:83], s43 offen offset:2048 lds
    buffer_load_dwordx4 v27, s[80:83], s43 offen offset:3072 lds
    s_add_u32 s43, s56, 2
    s_and_b32 s43, s43, 15
    s_lshl_b32 s43, s43, 17
    buffer_load_dwordx4 v[64:67], v24, s[80:83], s43 offen offset:0
    buffer_load_dwordx4 v[68:71], v25, s[80:83], s43 offen offset:1024
    buffer_load_dwordx4 v[72:75], v26, s[80:83], s43 offen offset:2048
    buffer_load_dwordx4 v[76:79], v27, s[80:83], s43 offen offset:3072
    s_add_u32 s43, s56, 3
    s_and_b32 s43, s43, 15
    s_lshl_b32 s43, s43, 17
    buffer_load_dwordx4 v[80:83], v24, s[80:83], s43 offen offset:0
    buffer_load_dwordx4 v[84:87], v25, s[80:83], s43 offen offset:1024
    buffer_load_dwordx4 v[88:91], v26, s[80:83], s43 offen offset:2048
    buffer_load_dwordx4 v[92:95], v27, s[80:83], s43 offen offset:3072
JOIN:
    s_lshl_b32 s42, s15, 2
    s_add_u32 s42, s42, s18
    s_lshl_b32 s42, s42, 7
    s_add_u32 s42, s42, 0x3000000
    v_and_b32 v5, 7, v0
    v_lshlrev_b32 v5, 3, v5
    s_lshl_b32 s92, 1, s19
    s_waitcnt vmcnt(0)
NONCE_CHK:
    v_cmp_eq_u32 vcc, 0, v28
    s_nop 1
    s_cbranch_vccz NONCE_OK
    s_sleep 8
    buffer_load_dwordx2 v[28:29], v7, s[76:79], 0 offen sc1
    s_waitcnt vmcnt(0)
    s_sub_u32 s58, s58, 1
    s_cmp_gt_i32 s58, 0
    s_cbranch_scc1 NONCE_CHK
NONCE_OK:
    s_mov_b64 exec, 1
    ds_write_b64 v9, v[28:29] offset:48
    s_mov_b64 exec, -1
    s_mov_b32 s94, 0
    v_mov_b32 v100, 0
    v_mov_b32 v101, 0
    s_lshl_b32 s47, 1, 2
    v_add_u32 v6, s47, v9
    s_cmp_lg_u32 s14, 4
    s_cbranch_scc1 DR_E
    s_andn2_b32 s46, s94, s92
    s_cbranch_scc1 DH_E
DP_E:
    buffer_load_dwordx2 v[30:31], v5, s[36:39], s42 offen sc1
    s_waitcnt vmcnt(0)
    v_cmp_eq_u64 vcc, v[30:31], v[28:29]
    s_nop 1
    s_and_b32 s94, vcc_lo, 0xff
    s_andn2_b32 s46, s94, s92
    s_cbranch_scc1 DH_E
    s_mov_b32 s93, 15
    s_branch DW_E
DH_E:
    s_lshl_b32 s47, s46, 8
    s_or_b32 s47, s47, s46
    s_lshr_b32 s47, s47, s19
    s_ff1_i32_b32 s47, s47
    s_add_u32 s47, s47, s19
    s_and_b32 s93, s47, 7
DW_E:
    s_add_u32 s47, s93, 1
    v_mov_b32 v4, s47
    s_mov_b64 exec, 1
    ds_write_b32 v6, v4 offset:64
    s_mov_b64 exec, -1
    s_branch DD_E
DR_E:
    ds_read_b32 v4, v6 offset:64
    s_waitcnt lgkmcnt(0)
    v_readfirstlane_b32 s47, v4
    s_nop 1
    s_sub_u32 s93, s47, 1
    s_and_b32 s93, s93, 15
    s_sub_u32 s58, s58, 1
    s_cmp_lt_i32 s58, 1
    s_cbranch_scc1 DD_E
    s_cmp_eq_u32 s47, 0
    s_cbranch_scc1 DR_E
DD_E:
    s_cmp_eq_u32 s93, 15
    s_cbranch_scc1 NOT_EARLY
    s_lshl_b32 s47, 1, s93
    s_or_b32 s92, s92, s47
    s_lshl_b32 s44, s93, 1
    s_add_u32 s44, s44, 0
    s_add_u32 s47, s41, 32768
    s_mov_b32 m0, s47
    s_lshl_b32 s43, s44, 14
    s_add_u32 s43, s43, s55
    buffer_load_dwordx4 v15, s[36:39], s43 offen offset:0 sc1 lds
    buffer_load_dwordx4 v15, s[36:39], s43 offen offset:1024 sc1 lds
    buffer_load_dwordx4 v15, s[36:39], s43 offen offset:2048 sc1 lds
    buffer_load_dwordx4 v15, s[36:39], s43 offen offset:3072 sc1 lds
    s_add_u32 m0, s47, 65536
    s_lshl_b32 s43, s44, 17
    buffer_load_dwordx4 v24, s[80:83], s43 offen offset:0 lds
    buffer_load_dwordx4 v25, s[80:83], s43 offen offset:1024 lds
    buffer_load_dwordx4 v26, s[80:83], s43 offen offset:2048 lds
    buffer_load_dwordx4 v27, s[80:83], s43 offen offset:3072 lds
NOT_EARLY:
    s_waitcnt lgkmcnt(0)
    s_barrier
    s_cmp_eq_u32 s93, 15
    s_cbranch_scc1 NOT_EARLY2
    buffer_load_dwordx2 v[100:101], v5, s[36:39], s42 offen sc1
    s_lshl_b32 s44, s93, 1
    s_add_u32 s44, s44, 1
    s_add_u32 s47, s41, 49152
    s_mov_b32 m0, s47
    s_lshl_b32 s43, s44, 14
    s_add_u32 s43, s43, s55
    buffer_load_dwordx4 v15, s[36:39], s43 offen offset:0 sc1 lds
    buffer_load_dwordx4 v15, s[36:39], s43 offen offset:1024 sc1 lds
    buffer_load_dwordx4 v15, s[36:39], s43 offen offset:2048 sc1 lds
    buffer_load_dwordx4 v15, s[36:39], s43 offen offset:3072 sc1 lds
    s_add_u32 m0, s47, 65536
    s_lshl_b32 s43, s44, 17
    buffer_load_dwordx4 v24, s[80:83], s43 offen offset:0 lds
    buffer_load_dwordx4 v25, s[80:83], s43 offen offset:1024 lds
    buffer_load_dwordx4 v26, s[80:83], s43 offen offset:2048 lds
    buffer_load_dwordx4 v27, s[80:83], s43 offen offset:3072 lds
NOT_EARLY2:
    s_barrier
    s_cmp_lg_u32 s93, 15
    s_cbranch_scc1 LATE_SKIP
    s_lshl_b32 s47, 2, 2
    v_add_u32 v6, s47, v9
    s_cmp_lg_u32 s14, 4
    s_cbranch_scc1 DR_L
    s_andn2_b32 s46, s94, s92
    s_cbranch_scc1 DH_L
DP_L:
    buffer_load_dwordx2 v[30:31], v5, s[36:39], s42 offen sc1
    s_waitcnt vmcnt(0)
    v_cmp_eq_u64 vcc, v[30:31], v[28:29]
    s_nop 1
    s_and_b32 s94, vcc_lo, 0xff
    s_andn2_b32 s46, s94, s92
    s_cbranch_scc1 DH_L
    s_sleep 1
    s_sub_u32 s58, s58, 1
    s_cmp_gt_i32 s58, 0
    s_cbranch_scc1 DP_L
    s_andn2_b32 s46, 0xff, s92
DH_L:
    s_lshl_b32 s47, s46, 8
    s_or_b32 s47, s47, s46
    s_lshr_b32 s47, s47, s19
    s_ff1_i32_b32 s47, s47
    s_add_u32 s47, s47, s19
    s_and_b32 s93, s47, 7
DW_L:
    s_add_u32 s47, s93, 1
    v_mov_b32 v4, s47
    s_mov_b64 exec, 1
    ds_write_b32 v6, v4 offset:64
    s_mov_b64 exec, -1
    s_branch DD_L
DR_L:
    ds_read_b32 v4, v6 offset:64
    s_waitcnt lgkmcnt(0)
    v_readfirstlane_b32 s47, v4
    s_nop 1
    s_sub_u32 s93, s47, 1
    s_and_b32 s93, s93, 15
    s_sub_u32 s58, s58, 1
    s_cmp_lt_i32 s58, 1
    s_cbranch_scc1 DD_L
    s_cmp_eq_u32 s47, 0
    s_cbranch_scc1 DR_L
DD_L:
    s_lshl_b32 s47, 1, s93
    s_or_b32 s92, s92, s47
    s_lshl_b32 s44, s93, 1
    s_add_u32 s44, s44, 0
    s_add_u32 s47, s41, 32768
    s_mov_b32 m0, s47
    s_lshl_b32 s43, s44, 14
    s_add_u32 s43, s43, s55
    buffer_load_dwordx4 v15, s[36:39], s43 offen offset:0 sc1 lds
    buffer_load_dwordx4 v15, s[36:39], s43 offen offset:1024 sc1 lds
    buffer_load_dwordx4 v15, s[36:39], s43 offen offset:2048 sc1 lds
    buffer_load_dwordx4 v15, s[36:39], s43 offen offset:3072 sc1 lds
    s_add_u32 m0, s47, 65536
    s_lshl_b32 s43, s44, 17
    buffer_load_dwordx4 v24, s[80:83], s43 offen offset:0 lds
    buffer_load_dwordx4 v25, s[80:83], s43 offen offset:1024 lds
    buffer_load_dwordx4 v26, s[80:83], s43 offen offset:2048 lds
    buffer_load_dwordx4 v27, s[80:83], s43 offen offset:3072 lds
    s_lshl_b32 s44, s93, 1
    s_add_u32 s44, s44, 1
    s_add_u32 s47, s41, 49152
    s_mov_b32 m0, s47
    s_lshl_b32 s43, s44, 14
    s_add_u32 s43, s43, s55
    buffer_load_dwordx4 v15, s[36:39], s43 offen offset:0 sc1 lds
    buffer_load_dwordx4 v15, s[36:39], s43 offen offset:1024 sc1 lds
    buffer_load_dwordx4 v15, s[36:39], s43 offen offset:2048 sc1 lds
    buffer_load_dwordx4 v15, s[36:39], s43 offen offset:3072 sc1 lds
    s_add_u32 m0, s47, 65536
    s_lshl_b32 s43, s44, 17
    buffer_load_dwordx4 v24, s[80:83], s43 offen offset:0 lds
    buffer_load_dwordx4 v25, s[80:83], s43 offen offset:1024 lds
    buffer_load_dwordx4 v26, s[80:83], s43 offen offset:2048 lds
    buffer_load_dwordx4 v27, s[80:83], s43 offen offset:3072 lds
LATE_SKIP:
    s_mov_b32 s50, 4
    s_branch LC_IN
LC:
    s_waitcnt vmcnt(16)
    s_barrier
LC_IN:
    s_bitcmp1_b32 s50, 0
    s_cbranch_scc1 LC_ODD
    s_lshl_b32 s47, s50, 2
    v_add_u32 v6, s47, v9
    s_cmp_lg_u32 s14, 4
    s_cbranch_scc1 DR_C
    s_waitcnt vmcnt(8)
    v_cmp_eq_u64 vcc, v[100:101], v[28:29]
    s_nop 1
    s_and_b32 s46, vcc_lo, 0xff
    s_or_b32 s94, s94, s46
    s_andn2_b32 s46, s94, s92
    s_cbranch_scc1 DH_C
DP_C:
    buffer_load_dwordx2 v[30:31], v5, s[36:39], s42 offen sc1
    s_waitcnt vmcnt(0)
    v_cmp_eq_u64 vcc, v[30:31], v[28:29]
    s_nop 1
    s_and_b32 s94, vcc_lo, 0xff
    s_andn2_b32 s46, s94, s92
    s_cbranch_scc1 DH_C
    s_sleep 1
    s_sub_u32 s58, s58, 1
    s_cmp_gt_i32 s58, 0
    s_cbranch_scc1 DP_C
    s_andn2_b32 s46, 0xff, s92
DH_C:
    s_lshl_b32 s47, s46, 8
    s_or_b32 s47, s47, s46
    s_lshr_b32 s47, s47, s19
    s_ff1_i32_b32 s47, s47
    s_add_u32 s47, s47, s19
    s_and_b32 s93, s47, 7
DW_C:
    s_add_u32 s47, s93, 1
    v_mov_b32 v4, s47
    s_mov_b64 exec, 1
    ds_write_b32 v6, v4 offset:64
    s_mov_b64 exec, -1
    s_branch DD_C
DR_C:
    ds_read_b32 v4, v6 offset:64
    s_waitcnt lgkmcnt(0)
    v_readfirstlane_b32 s47, v4
    s_nop 1
    s_sub_u32 s93, s47, 1
    s_and_b32 s93, s93, 15
    s_sub_u32 s58, s58, 1
    s_cmp_lt_i32 s58, 1
    s_cbranch_scc1 DD_C
    s_cmp_eq_u32 s47, 0
    s_cbranch_scc1 DR_C
DD_C:
    s_lshl_b32 s47, 1, s93
    s_or_b32 s92, s92, s47
    s_branch LC_ISSUE
LC_ODD:
    s_cmp_lg_u32 s14, 4
    s_cbranch_scc1 LC_ISSUE
    buffer_load_dwordx2 v[100:101], v5, s[36:39], s42 offen sc1
LC_ISSUE:
    s_and_b32 s48, s50, 3
    s_lshl_b32 s48, s48, 14
    s_and_b32 s49, s50, 1
    s_lshl_b32 s44, s93, 1
    s_add_u32 s44, s44, s49
    s_add_u32 s47, s41, s48
    s_mov_b32 m0, s47
    s_lshl_b32 s43, s44, 14
    s_add_u32 s43, s43, s55
    buffer_load_dwordx4 v15, s[36:39], s43 offen offset:0 sc1 lds
    buffer_load_dwordx4 v15, s[36:39], s43 offen offset:1024 sc1 lds
    buffer_load_dwordx4 v15, s[36:39], s43 offen offset:2048 sc1 lds
    buffer_load_dwordx4 v15, s[36:39], s43 offen offset:3072 sc1 lds
    s_add_u32 m0, s47, 65536
    s_lshl_b32 s43, s44, 17
    buffer_load_dwordx4 v24, s[80:83], s43 offen offset:0 lds
    buffer_load_dwordx4 v25, s[80:83], s43 offen offset:1024 lds
    buffer_load_dwordx4 v26, s[80:83], s43 offen offset:2048 lds
    buffer_load_dwordx4 v27, s[80:83], s43 offen offset:3072 lds
    s_add_u32 s50, s50, 1
    s_cmp_lt_u32 s50, 16
    s_cbranch_scc1 LC
    s_waitcnt vmcnt(16)
    s_barrier
    s_waitcnt vmcnt(8)
    s_barrier
    s_waitcnt vmcnt(0)
    s_barrier
    s_cmp_lg_u32 s14, 4
    s_cbranch_scc1 LDONE
    s_barrier
    s_lshl_b32 s42, s15, 3
    s_add_u32 s42, s42, s19
    s_lshl_b32 s42, s42, 7
    s_add_u32 s42, s42, 0x3002000
    s_lshl_b32 s43, s18, 3
    s_add_u32 s43, s43, s42
    v_and_b32 v5, 3, v0
    v_lshlrev_b32 v5, 3, v5
    s_barrier
    s_mov_b64 exec, 1
    buffer_store_dwordx2 v[28:29], v7, s[36:39], s43 offen sc1
    s_mov_b64 exec, -1
POLL2:
    buffer_load_dwordx2 v[30:31], v5, s[36:39], s42 offen sc1
    s_waitcnt vmcnt(0)
    v_cmp_ne_u64 vcc, v[30:31], v[28:29]
    s_nop 1
    s_cbranch_vccz POLL2_OK
    s_sleep 1
    s_sub_u32 s58, s58, 1
    s_cmp_gt_i32 s58, 0
    s_cbranch_scc1 POLL2
POLL2_OK:
    s_barrier
LDONE:
K1_END:
    s_endpgm
.section .rodata,"a"
.p2align 6
.amdhsa_kernel standalone__mha_block_cached__near_ridge_kernel
  .amdhsa_next_free_vgpr 256
  .amdhsa_next_free_sgpr 100
  .amdhsa_accum_offset 256
  .amdhsa_group_segment_fixed_size 0
  .amdhsa_kernarg_size 64
  .amdhsa_user_sgpr_count 2
  .amdhsa_user_sgpr_kernarg_segment_ptr 1
  .amdhsa_system_sgpr_workgroup_id_x 1
.end_amdhsa_kernel
```
